```python
import torch

def _softmax(x, axis=-1):
    return torch.softmax(x, dim=axis)
def _gelu(x):
    return torch.nn.functional.gelu(x, approximate="tanh")
def _silu(x):
    return torch.nn.functional.silu(x)
def _sigmoid(x):
    return torch.sigmoid(x)
def _layernorm(x, axis=-1, eps=1e-5):
    m = x.mean(dim=axis, keepdim=True)
    v = x.var(dim=axis, keepdim=True, unbiased=False)
    return (x - m) / torch.sqrt(v + eps)
def _scatter_add(tgt, idx, src, axis=0):
    return tgt.clone().index_add_(axis, idx, src)
def _segment_sum(src, seg, n):
    out = torch.zeros((n,) + src.shape[1:], dtype=src.dtype)
    return out.index_add_(0, seg, src)
def _pad(x, pw):
    flat = tuple(v for pair in reversed(pw) for v in pair)
    return torch.nn.functional.pad(x, flat)

kernel_name = 'standalone__gqa_softmax__near_ridge'

def setup_inputs():

    _w = (lambda a: (lambda t: t.to(torch.bfloat16) if t.is_floating_point() else t)(torch.as_tensor(a)))
    B, Hq, Hkv, Sq, Sk, D = 32, 32, 4, 256, 256, 128
    return {
        "q": _w((lambda *s: torch.randn(*s, dtype=torch.bfloat16) * 0.8)(B, Hq, Sq, D)),
        "k": _w((lambda *s: torch.randn(*s, dtype=torch.bfloat16) * 0.8)(B, Hkv, Sk, D)),
        "v": _w((lambda *s: torch.randn(*s, dtype=torch.bfloat16) * 0.05)(B, Hkv, Sk, D)),
    }

def reference(q, k, v):
    B, Hq, Sq, D = q.shape
    Hkv = k.shape[1]
    rep = Hq // Hkv
    k = (lambda x, n, axis: torch.repeat_interleave(x, n, dim=axis))(k, rep, axis=1)
    v = (lambda x, n, axis: torch.repeat_interleave(x, n, dim=axis))(v, rep, axis=1)
    scale = D ** -0.5
    scores = torch.einsum("bhqd,bhkd->bhqk", q, k) * scale
    p = _softmax(scores, axis=-1)
    return torch.einsum("bhqk,bhkd->bhqd", p, v)
```

```asm
; @launch grid=(256,1,1) block=(256,1,1) lds=163840
.amdgcn_target "amdgcn-amd-amdhsa--gfx950"
.text
.globl standalone__gqa_softmax__near_ridge_kernel
.p2align 8
.type standalone__gqa_softmax__near_ridge_kernel,@function
standalone__gqa_softmax__near_ridge_kernel:
    s_cmp_ge_u32 s2, 256
    s_cbranch_scc1 L_end
    s_load_dwordx4 s[4:7], s[0:1], 0
    s_load_dwordx4 s[8:11], s[0:1], 16
    s_getpc_b64 s[44:45]
L_pc:
    v_lshlrev_b32 v30, 7, v0
    v_min_u32 v30, L_end-L_pc, v30
    global_load_dword v31, v30, s[44:45]
    v_lshrrev_b32 v28, 6, v0
    v_and_b32 v0, 63, v0
    v_readfirstlane_b32 s3, v28
    v_and_b32 v28, 7, v0
    v_lshlrev_b32 v4, 8, v28
    v_lshrrev_b32 v29, 3, v0
    v_lshl_add_u32 v4, v29, 4, v4
    s_and_b32 s39, s2, 7
    s_lshr_b32 s40, s2, 4
    s_lshl_b32 s40, s40, 3
    s_add_u32 s39, s39, s40
    s_lshl_b32 s40, s2, 15
    s_and_b32 s40, s40, 0x40000
    s_lshl_b32 s41, s39, 19
    s_add_u32 s41, s41, s40
    s_lshl_b32 s42, s39, 16
    s_lshl_b32 s36, s3, 12
    s_lshl_b32 s39, s3, 11
    s_lshl_b32 s31, s3, 13
    s_add_u32 s31, s31, 0x20000
    s_mov_b32 s28, s36
    s_add_u32 s29, s36, 128
    s_mov_b32 s30, s36
    v_lshlrev_b32 v1, 4, v28
    v_and_b32 v29, 1, v29
    v_lshl_add_u32 v1, v29, 11, v1
    v_lshrrev_b32 v29, 4, v0
    v_lshl_add_u32 v1, v29, 7, v1
    v_and_b32 v28, 15, v0
    v_lshlrev_b32 v5, 4, v28
    v_lshl_add_u32 v5, v29, 10, v5
    v_lshlrev_b32 v6, 4, v0
    v_add_u32 v2, 0x10000, v6
    s_mov_b32 s14, 262144
    s_mov_b32 s15, 0x20000
    s_mov_b32 s18, 65536
    s_mov_b32 s19, 0x20000
    s_mov_b32 s22, 65536
    s_mov_b32 s23, 0x20000
    s_mov_b32 s26, 262144
    s_mov_b32 s27, 0x20000
    s_waitcnt lgkmcnt(0)
    s_add_u32 s16, s6, s42
    s_addc_u32 s17, s7, 0
    s_add_u32 s12, s4, s41
    s_addc_u32 s13, s5, 0
    s_add_u32 s20, s8, s42
    s_addc_u32 s21, s9, 0
    s_add_u32 s24, s10, s41
    s_addc_u32 s25, s11, 0
    s_mov_b32 s8, s39
    s_mov_b32 s9, s36
    buffer_load_dwordx4 v[160:163], v4, s[16:19], s8 offen offset:0 nt
    buffer_load_dwordx4 v[164:167], v4, s[16:19], s8 offen offset:128 nt
    s_add_u32 s8, s8, 0x2000
    s_add_u32 m0, s31, 0
    s_nop 0
    buffer_load_dwordx4 v4, s[12:15], s28 offen offset:0 nt lds
    buffer_load_dwordx4 v4, s[12:15], s28 offen offset:2048 nt lds
    s_add_u32 m0, s31, 1024
    s_nop 0
    buffer_load_dwordx4 v4, s[12:15], s29 offen offset:0 nt lds
    buffer_load_dwordx4 v4, s[12:15], s29 offen offset:2048 nt lds
    s_add_u32 s28, s28, 0x4000
    s_add_u32 s29, s29, 0x4000
    buffer_load_dwordx4 v[168:171], v4, s[16:19], s8 offen offset:0 nt
    buffer_load_dwordx4 v[172:175], v4, s[16:19], s8 offen offset:128 nt
    s_add_u32 s8, s8, 0x2000
    buffer_load_dwordx4 v[208:211], v5, s[20:23], s9 offen offset:0 nt
    buffer_load_dwordx4 v[212:215], v5, s[20:23], s9 offen offset:256 nt
    buffer_load_dwordx4 v[216:219], v5, s[20:23], s9 offen offset:512 nt
    buffer_load_dwordx4 v[220:223], v5, s[20:23], s9 offen offset:768 nt
    s_add_u32 s9, s9, 0x4000
    v_add_u32 v3, s31, v1
    v_add_u32 v6, s39, v6
    s_and_b32 s35, s3, 1
    s_lshl_b32 s35, s35, 3
    s_lshr_b32 s40, s3, 1
    s_lshl_b32 s40, s40, 13
    s_add_u32 s35, s35, s40
    v_add_u32 v7, s35, v2
    s_mov_b32 s7, 0x3e0293ee
    s_mov_b32 s6, 0xffff0000
    s_mov_b32 s4, 0x05040100
    s_mov_b32 s5, 0x07060302
    s_mov_b32 s33, 0
    s_mov_b32 s34, 1
    s_mov_b32 s32, 0
    s_mov_b32 s38, 0x4f800000
    s_mov_b32 s43, 0x2f800000
    v_mov_b32 v28, 0x3f803f80
    v_accvgpr_write_b32 a192, v28
    v_accvgpr_write_b32 a193, v28
    v_accvgpr_write_b32 a194, v28
    v_accvgpr_write_b32 a195, v28
    v_mov_b32 v28, 1.0
    v_mov_b32 v29, 1.0
    s_waitcnt vmcnt(10)
    buffer_load_dwordx4 v[176:179], v4, s[16:19], s8 offen offset:0 nt
    buffer_load_dwordx4 v[180:183], v4, s[16:19], s8 offen offset:128 nt
    s_add_u32 s8, s8, 0x2000
    v_lshlrev_b32 v8, 16, v160
    v_and_b32 v9, s6, v160
    v_lshlrev_b32 v10, 16, v161
    v_and_b32 v11, s6, v161
    v_lshlrev_b32 v12, 16, v162
    v_and_b32 v13, s6, v162
    v_lshlrev_b32 v14, 16, v163
    v_and_b32 v15, s6, v163
    v_mul_f32 v8, s7, v8
    v_mul_f32 v9, s7, v9
    v_mul_f32 v10, s7, v10
    v_mul_f32 v11, s7, v11
    v_mul_f32 v12, s7, v12
    v_mul_f32 v13, s7, v13
    v_mul_f32 v14, s7, v14
    v_mul_f32 v15, s7, v15
    v_cvt_pk_bf16_f32 v160, v8, v9
    v_cvt_pk_bf16_f32 v161, v10, v11
    v_cvt_pk_bf16_f32 v162, v12, v13
    v_cvt_pk_bf16_f32 v163, v14, v15
    ds_write_b128 v6, v[160:163] offset:0
    v_lshlrev_b32 v16, 16, v164
    v_and_b32 v17, s6, v164
    v_lshlrev_b32 v18, 16, v165
    v_and_b32 v19, s6, v165
    v_lshlrev_b32 v20, 16, v166
    v_and_b32 v21, s6, v166
    v_lshlrev_b32 v22, 16, v167
    v_and_b32 v23, s6, v167
    v_mul_f32 v16, s7, v16
    v_mul_f32 v17, s7, v17
    v_mul_f32 v18, s7, v18
    v_mul_f32 v19, s7, v19
    v_mul_f32 v20, s7, v20
    v_mul_f32 v21, s7, v21
    v_mul_f32 v22, s7, v22
    v_mul_f32 v23, s7, v23
    v_cvt_pk_bf16_f32 v164, v16, v17
    v_cvt_pk_bf16_f32 v165, v18, v19
    v_cvt_pk_bf16_f32 v166, v20, v21
    v_cvt_pk_bf16_f32 v167, v22, v23
    ds_write_b128 v6, v[164:167] offset:1024
    s_waitcnt lgkmcnt(0)
    s_barrier
    ds_read_b128 a[64:67], v1 offset:0
    ds_read_b128 a[68:71], v1 offset:512
    ds_read_b128 a[72:75], v1 offset:1024
    ds_read_b128 a[76:79], v1 offset:1536
    ds_read_b128 a[80:83], v1 offset:4096
    ds_read_b128 a[84:87], v1 offset:4608
    ds_read_b128 a[88:91], v1 offset:5120
    ds_read_b128 a[92:95], v1 offset:5632
    s_add_u32 m0, s31, 4096
    s_nop 0
    buffer_load_dwordx4 v4, s[12:15], s28 offen offset:0 nt lds
    buffer_load_dwordx4 v4, s[12:15], s28 offen offset:2048 nt lds
    s_add_u32 m0, s31, 5120
    s_nop 0
    buffer_load_dwordx4 v4, s[12:15], s29 offen offset:0 nt lds
    buffer_load_dwordx4 v4, s[12:15], s29 offen offset:2048 nt lds
    s_add_u32 s28, s28, 0x4000
    s_add_u32 s29, s29, 0x4000
    s_waitcnt vmcnt(12)
    ds_read_b128 a[0:3], v3 offset:0
    ds_read_b128 a[4:7], v3 offset:512
    ds_read_b128 a[8:11], v3 offset:1024
    ds_read_b128 a[12:15], v3 offset:1536
    buffer_load_dwordx4 v[184:187], v4, s[16:19], s8 offen offset:0 nt
    buffer_load_dwordx4 v[188:191], v4, s[16:19], s8 offen offset:128 nt
    s_add_u32 s8, s8, 0x2000
    s_waitcnt lgkmcnt(0)
    v_mfma_f32_16x16x32_bf16 v[80:83], a[64:67], a[0:3], 0
    s_waitcnt vmcnt(8)
    buffer_load_dwordx4 v[32:35], v5, s[20:23], s9 offen offset:0 nt
    v_mfma_f32_16x16x32_bf16 v[80:83], a[68:71], a[4:7], v[80:83]
    buffer_load_dwordx4 v[36:39], v5, s[20:23], s9 offen offset:256 nt
    v_mfma_f32_16x16x32_bf16 v[80:83], a[72:75], a[8:11], v[80:83]
    buffer_load_dwordx4 v[40:43], v5, s[20:23], s9 offen offset:512 nt
    v_mfma_f32_16x16x32_bf16 v[80:83], a[76:79], a[12:15], v[80:83]
    buffer_load_dwordx4 v[44:47], v5, s[20:23], s9 offen offset:768 nt
    v_mfma_f32_16x16x32_bf16 v[84:87], a[80:83], a[0:3], 0
    s_add_u32 s9, s9, 0x4000
    buffer_load_dwordx4 v[192:195], v4, s[16:19], s8 offen offset:0 nt
    v_mfma_f32_16x16x32_bf16 v[84:87], a[84:87], a[4:7], v[84:87]
    buffer_load_dwordx4 v[196:199], v4, s[16:19], s8 offen offset:128 nt
    v_mfma_f32_16x16x32_bf16 v[84:87], a[88:91], a[8:11], v[84:87]
    s_add_u32 s8, s8, 0x2000
    v_perm_b32 v8, v212, v208, s4
    v_perm_b32 v9, v220, v216, s4
    v_mfma_f32_16x16x32_bf16 v[84:87], a[92:95], a[12:15], v[84:87]
    ds_write_b64 v7, v[8:9] offset:0
    v_exp_f32 v80, v80
    v_exp_f32 v81, v81
    v_exp_f32 v82, v82
    v_exp_f32 v83, v83
    s_nop 2
    v_exp_f32 v84, v84
    v_exp_f32 v85, v85
    v_exp_f32 v86, v86
    v_exp_f32 v87, v87
    v_cvt_pk_bf16_f32 v64, v80, v81
    v_cvt_pk_bf16_f32 v65, v82, v83
    v_cvt_pk_bf16_f32 v66, v84, v85
    v_cvt_pk_bf16_f32 v67, v86, v87
    v_perm_b32 v10, v212, v208, s5
    v_perm_b32 v11, v220, v216, s5
    ds_write_b64 v7, v[10:11] offset:1024
    v_perm_b32 v12, v213, v209, s4
    v_perm_b32 v13, v221, v217, s4
    ds_write_b64 v7, v[12:13] offset:2048
    v_perm_b32 v14, v213, v209, s5
    v_perm_b32 v15, v221, v217, s5
    ds_write_b64 v7, v[14:15] offset:3072
    v_perm_b32 v16, v214, v210, s4
    v_perm_b32 v17, v222, v218, s4
    ds_write_b64 v7, v[16:17] offset:4096
    v_perm_b32 v18, v214, v210, s5
    v_perm_b32 v19, v222, v218, s5
    ds_write_b64 v7, v[18:19] offset:5120
    v_perm_b32 v20, v215, v211, s4
    v_perm_b32 v21, v223, v219, s4
    ds_write_b64 v7, v[20:21] offset:6144
    v_perm_b32 v22, v215, v211, s5
    v_perm_b32 v23, v223, v219, s5
    ds_write_b64 v7, v[22:23] offset:7168
    v_lshlrev_b32 v8, 16, v168
    v_and_b32 v9, s6, v168
    v_lshlrev_b32 v10, 16, v169
    v_and_b32 v11, s6, v169
    v_lshlrev_b32 v12, 16, v170
    v_and_b32 v13, s6, v170
    v_lshlrev_b32 v14, 16, v171
    v_and_b32 v15, s6, v171
    v_mul_f32 v8, s7, v8
    v_mul_f32 v9, s7, v9
    v_mul_f32 v10, s7, v10
    v_mul_f32 v11, s7, v11
    v_mul_f32 v12, s7, v12
    v_mul_f32 v13, s7, v13
    v_mul_f32 v14, s7, v14
    v_mul_f32 v15, s7, v15
    v_cvt_pk_bf16_f32 v168, v8, v9
    v_cvt_pk_bf16_f32 v169, v10, v11
    v_cvt_pk_bf16_f32 v170, v12, v13
    v_cvt_pk_bf16_f32 v171, v14, v15
    ds_write_b128 v6, v[168:171] offset:8192
    v_lshlrev_b32 v16, 16, v172
    v_and_b32 v17, s6, v172
    v_lshlrev_b32 v18, 16, v173
    v_and_b32 v19, s6, v173
    v_lshlrev_b32 v20, 16, v174
    v_and_b32 v21, s6, v174
    v_lshlrev_b32 v22, 16, v175
    v_and_b32 v23, s6, v175
    v_mul_f32 v16, s7, v16
    v_mul_f32 v17, s7, v17
    v_mul_f32 v18, s7, v18
    v_mul_f32 v19, s7, v19
    v_mul_f32 v20, s7, v20
    v_mul_f32 v21, s7, v21
    v_mul_f32 v22, s7, v22
    v_mul_f32 v23, s7, v23
    v_cvt_pk_bf16_f32 v172, v16, v17
    v_cvt_pk_bf16_f32 v173, v18, v19
    v_cvt_pk_bf16_f32 v174, v20, v21
    v_cvt_pk_bf16_f32 v175, v22, v23
    ds_write_b128 v6, v[172:175] offset:9216
    s_waitcnt lgkmcnt(0)
    s_barrier
    ds_read_b128 a[96:99], v1 offset:8192
    ds_read_b128 a[100:103], v1 offset:8704
    ds_read_b128 a[104:107], v1 offset:9216
    ds_read_b128 a[108:111], v1 offset:9728
    ds_read_b128 a[112:115], v1 offset:12288
    ds_read_b128 a[116:119], v1 offset:12800
    ds_read_b128 a[120:123], v1 offset:13312
    ds_read_b128 a[124:127], v1 offset:13824
    ds_read_b128 a[160:163], v2 offset:0
    ds_read_b128 a[164:167], v2 offset:1024
    ds_read_b128 a[168:171], v2 offset:2048
    ds_read_b128 a[172:175], v2 offset:3072
    ds_read_b128 a[176:179], v2 offset:4096
    ds_read_b128 a[180:183], v2 offset:5120
    ds_read_b128 a[184:187], v2 offset:6144
    ds_read_b128 a[188:191], v2 offset:7168
    s_waitcnt lgkmcnt(15)
    v_mfma_f32_16x16x32_bf16 v[80:83], a[96:99], a[0:3], 0
    s_waitcnt vmcnt(12)
    s_add_u32 m0, s31, 0
    buffer_load_dwordx4 v[200:203], v4, s[16:19], s8 offen offset:0 nt
    s_waitcnt lgkmcnt(14)
    v_mfma_f32_16x16x32_bf16 v[80:83], a[100:103], a[4:7], v[80:83]
    buffer_load_dwordx4 v[204:207], v4, s[16:19], s8 offen offset:128 nt
    s_waitcnt lgkmcnt(13)
    v_mfma_f32_16x16x32_bf16 v[80:83], a[104:107], a[8:11], v[80:83]
    s_add_u32 s8, s8, 0x2000
    v_lshlrev_b32 v8, 16, v176
    v_and_b32 v9, s6, v176
    v_lshlrev_b32 v10, 16, v177
    s_waitcnt lgkmcnt(12)
    v_mfma_f32_16x16x32_bf16 v[80:83], a[108:111], a[12:15], v[80:83]
    v_and_b32 v11, s6, v177
    v_lshlrev_b32 v12, 16, v178
    v_and_b32 v13, s6, v178
    s_waitcnt lgkmcnt(11)
    v_mfma_f32_16x16x32_bf16 v[84:87], a[112:115], a[0:3], 0
    v_lshlrev_b32 v14, 16, v179
    v_and_b32 v15, s6, v179
    v_mul_f32 v8, s7, v8
    s_waitcnt lgkmcnt(10)
    v_mfma_f32_16x16x32_bf16 v[84:87], a[116:119], a[4:7], v[84:87]
    v_mul_f32 v9, s7, v9
    v_mul_f32 v10, s7, v10
    v_mul_f32 v11, s7, v11
    s_waitcnt lgkmcnt(9)
    v_mfma_f32_16x16x32_bf16 v[84:87], a[120:123], a[8:11], v[84:87]
    v_mul_f32 v12, s7, v12
    v_mul_f32 v13, s7, v13
    v_mul_f32 v14, s7, v14
    s_waitcnt lgkmcnt(8)
    v_mfma_f32_16x16x32_bf16 v[84:87], a[124:127], a[12:15], v[84:87]
    s_waitcnt lgkmcnt(0)
    v_mul_f32 v15, s7, v15
    v_cvt_pk_bf16_f32 v176, v8, v9
    v_cvt_pk_bf16_f32 v177, v10, v11
    v_mfma_f32_16x16x32_bf16 v[128:131], v[64:67], a[160:163], 0
    v_cvt_pk_bf16_f32 v178, v12, v13
    v_cvt_pk_bf16_f32 v179, v14, v15
    ds_write_b128 v6, v[176:179] offset:16384
    v_lshlrev_b32 v16, 16, v180
    v_and_b32 v17, s6, v180
    v_lshlrev_b32 v18, 16, v181
    v_and_b32 v19, s6, v181
    v_lshlrev_b32 v20, 16, v182
    v_and_b32 v21, s6, v182
    v_lshlrev_b32 v22, 16, v183
    v_and_b32 v23, s6, v183
    v_mul_f32 v16, s7, v16
    v_mul_f32 v17, s7, v17
    v_mul_f32 v18, s7, v18
    v_mul_f32 v19, s7, v19
    v_mul_f32 v20, s7, v20
    v_mul_f32 v21, s7, v21
    v_mul_f32 v22, s7, v22
    v_mul_f32 v23, s7, v23
    v_cvt_pk_bf16_f32 v180, v16, v17
    v_cvt_pk_bf16_f32 v181, v18, v19
    v_cvt_pk_bf16_f32 v182, v20, v21
    v_cvt_pk_bf16_f32 v183, v22, v23
    ds_write_b128 v6, v[180:183] offset:17408
    s_waitcnt lgkmcnt(0)
    s_barrier
    v_mfma_f32_16x16x32_bf16 v[132:135], v[64:67], a[164:167], 0
    ds_read_b128 a[64:67], v1 offset:16384
    ds_read_b128 a[68:71], v1 offset:16896
    v_mfma_f32_16x16x32_bf16 v[136:139], v[64:67], a[168:171], 0
    buffer_load_dwordx4 v4, s[12:15], s28 offen offset:0 nt lds
    v_mfma_f32_16x16x32_bf16 v[140:143], v[64:67], a[172:175], 0
    ds_read_b128 a[72:75], v1 offset:17408
    ds_read_b128 a[76:79], v1 offset:17920
    ds_read_b128 a[80:83], v1 offset:20480
    ds_read_b128 a[84:87], v1 offset:20992
    ds_read_b128 a[88:91], v1 offset:21504
    ds_read_b128 a[92:95], v1 offset:22016
    ds_read_b128 a[128:131], v2 offset:8192
    ds_read_b128 a[132:135], v2 offset:9216
    ds_read_b128 a[136:139], v2 offset:10240
    ds_read_b128 a[140:143], v2 offset:11264
    ds_read_b128 a[144:147], v2 offset:12288
    ds_read_b128 a[148:151], v2 offset:13312
    ds_read_b128 a[152:155], v2 offset:14336
    ds_read_b128 a[156:159], v2 offset:15360
    v_mfma_f32_16x16x32_bf16 v[144:147], v[64:67], a[176:179], 0
    buffer_load_dwordx4 v4, s[12:15], s28 offen offset:2048 nt lds
    v_mfma_f32_16x16x32_bf16 v[148:151], v[64:67], a[180:183], 0
    s_waitcnt vmcnt(12)
    ds_read_b128 a[16:19], v3 offset:4096
    ds_read_b128 a[20:23], v3 offset:4608
    ds_read_b128 a[24:27], v3 offset:5120
    ds_read_b128 a[28:31], v3 offset:5632
    v_mfma_f32_16x16x32_bf16 v[152:155], v[64:67], a[184:187], 0
    s_add_u32 m0, s31, 1024
    v_exp_f32 v80, v80
    v_mfma_f32_16x16x32_bf16 v[156:159], v[64:67], a[188:191], 0
    buffer_load_dwordx4 v4, s[12:15], s29 offen offset:0 nt lds
    v_mfma_f32_16x16x32_bf16 v[112:115], v[64:67], a[192:195], 0
    buffer_load_dwordx4 v4, s[12:15], s29 offen offset:2048 nt lds
    s_add_u32 s28, s28, 0x4000
    s_add_u32 s29, s29, 0x4000
    s_waitcnt lgkmcnt(0)
    v_mfma_f32_16x16x32_bf16 v[88:91], a[64:67], a[16:19], 0
    s_waitcnt vmcnt(8)
    v_exp_f32 v81, v81
    v_mfma_f32_16x16x32_bf16 v[88:91], a[68:71], a[20:23], v[88:91]
    s_add_u32 m0, s31, 4096
    v_exp_f32 v82, v82
    v_mfma_f32_16x16x32_bf16 v[88:91], a[72:75], a[24:27], v[88:91]
    v_exp_f32 v83, v83
    v_mfma_f32_16x16x32_bf16 v[88:91], a[76:79], a[28:31], v[88:91]
    v_exp_f32 v84, v84
    v_mfma_f32_16x16x32_bf16 v[92:95], a[80:83], a[16:19], 0
    v_exp_f32 v85, v85
    v_mfma_f32_16x16x32_bf16 v[92:95], a[84:87], a[20:23], v[92:95]
    v_exp_f32 v86, v86
    v_exp_f32 v87, v87
    v_mfma_f32_16x16x32_bf16 v[92:95], a[88:91], a[24:27], v[92:95]
    v_cvt_pk_bf16_f32 v64, v80, v81
    v_cvt_pk_bf16_f32 v65, v82, v83
    v_cvt_pk_bf16_f32 v66, v84, v85
    v_mfma_f32_16x16x32_bf16 v[92:95], a[92:95], a[28:31], v[92:95]
    buffer_load_dwordx4 v[240:243], v5, s[20:23], s9 offen offset:0 nt
    v_cvt_pk_bf16_f32 v67, v86, v87
    v_mfma_f32_16x16x32_bf16 v[80:83], a[64:67], a[0:3], 0
    buffer_load_dwordx4 v[244:247], v5, s[20:23], s9 offen offset:256 nt
    v_mfma_f32_16x16x32_bf16 v[80:83], a[68:71], a[4:7], v[80:83]
    buffer_load_dwordx4 v[248:251], v5, s[20:23], s9 offen offset:512 nt
    v_mfma_f32_16x16x32_bf16 v[80:83], a[72:75], a[8:11], v[80:83]
    buffer_load_dwordx4 v[252:255], v5, s[20:23], s9 offen offset:768 nt
    s_add_u32 s9, s9, 0x4000
    buffer_load_dwordx4 v[224:227], v4, s[16:19], s8 offen offset:0 nt
    buffer_load_dwordx4 v[228:231], v4, s[16:19], s8 offen offset:128 nt
    s_add_u32 s8, s8, 0x2000
    v_perm_b32 v8, v36, v32, s4
    v_perm_b32 v9, v44, v40, s4
    ds_write_b64 v7, v[8:9] offset:16384
    v_perm_b32 v10, v36, v32, s5
    v_perm_b32 v11, v44, v40, s5
    ds_write_b64 v7, v[10:11] offset:17408
    v_perm_b32 v12, v37, v33, s4
    v_perm_b32 v13, v45, v41, s4
    ds_write_b64 v7, v[12:13] offset:18432
    v_perm_b32 v14, v37, v33, s5
    v_perm_b32 v15, v45, v41, s5
    ds_write_b64 v7, v[14:15] offset:19456
    v_perm_b32 v16, v38, v34, s4
    v_perm_b32 v17, v46, v42, s4
    ds_write_b64 v7, v[16:17] offset:20480
    v_perm_b32 v18, v38, v34, s5
    v_perm_b32 v19, v46, v42, s5
    ds_write_b64 v7, v[18:19] offset:21504
    v_perm_b32 v20, v39, v35, s4
    v_perm_b32 v21, v47, v43, s4
    ds_write_b64 v7, v[20:21] offset:22528
    v_perm_b32 v22, v39, v35, s5
    v_perm_b32 v23, v47, v43, s5
    ds_write_b64 v7, v[22:23] offset:23552
    v_lshlrev_b32 v8, 16, v184
    v_and_b32 v9, s6, v184
    v_lshlrev_b32 v10, 16, v185
    v_and_b32 v11, s6, v185
    v_lshlrev_b32 v12, 16, v186
    v_and_b32 v13, s6, v186
    v_lshlrev_b32 v14, 16, v187
    v_and_b32 v15, s6, v187
    v_mul_f32 v8, s7, v8
    v_mul_f32 v9, s7, v9
    v_mul_f32 v10, s7, v10
    v_mul_f32 v11, s7, v11
    v_mul_f32 v12, s7, v12
    v_mul_f32 v13, s7, v13
    v_mul_f32 v14, s7, v14
    v_mul_f32 v15, s7, v15
    v_cvt_pk_bf16_f32 v184, v8, v9
    v_cvt_pk_bf16_f32 v185, v10, v11
    v_cvt_pk_bf16_f32 v186, v12, v13
    v_cvt_pk_bf16_f32 v187, v14, v15
    ds_write_b128 v6, v[184:187] offset:24576
    v_lshlrev_b32 v16, 16, v188
    v_and_b32 v17, s6, v188
    v_lshlrev_b32 v18, 16, v189
    v_and_b32 v19, s6, v189
    v_lshlrev_b32 v20, 16, v190
    v_and_b32 v21, s6, v190
    v_lshlrev_b32 v22, 16, v191
    v_and_b32 v23, s6, v191
    v_mul_f32 v16, s7, v16
    v_mul_f32 v17, s7, v17
    v_mul_f32 v18, s7, v18
    v_mul_f32 v19, s7, v19
    v_mul_f32 v20, s7, v20
    v_mul_f32 v21, s7, v21
    v_mul_f32 v22, s7, v22
    v_mul_f32 v23, s7, v23
    v_cvt_pk_bf16_f32 v188, v16, v17
    v_cvt_pk_bf16_f32 v189, v18, v19
    v_cvt_pk_bf16_f32 v190, v20, v21
    v_cvt_pk_bf16_f32 v191, v22, v23
    ds_write_b128 v6, v[188:191] offset:25600
    s_waitcnt lgkmcnt(0)
    s_barrier
    v_mfma_f32_16x16x32_bf16 v[80:83], a[76:79], a[12:15], v[80:83]
    ds_read_b128 a[96:99], v1 offset:24576
    v_exp_f32 v88, v88
    v_mfma_f32_16x16x32_bf16 v[84:87], a[80:83], a[0:3], 0
    v_exp_f32 v89, v89
    v_mfma_f32_16x16x32_bf16 v[84:87], a[84:87], a[4:7], v[84:87]
    v_exp_f32 v90, v90
    v_exp_f32 v91, v91
    v_exp_f32 v92, v92
    v_exp_f32 v93, v93
    v_exp_f32 v94, v94
    v_exp_f32 v95, v95
    v_mfma_f32_16x16x32_bf16 v[84:87], a[88:91], a[8:11], v[84:87]
    ds_read_b128 a[100:103], v1 offset:25088
    ds_read_b128 a[104:107], v1 offset:25600
    v_cvt_pk_bf16_f32 v68, v88, v89
    v_mfma_f32_16x16x32_bf16 v[84:87], a[92:95], a[12:15], v[84:87]
    v_cvt_pk_bf16_f32 v69, v90, v91
    v_cvt_pk_bf16_f32 v70, v92, v93
    v_cvt_pk_bf16_f32 v71, v94, v95
    v_mfma_f32_16x16x32_bf16 v[128:131], v[64:67], a[128:131], v[128:131]
    ds_read_b128 a[108:111], v1 offset:26112
    ds_read_b128 a[112:115], v1 offset:28672
    v_mfma_f32_16x16x32_bf16 v[132:135], v[64:67], a[132:135], v[132:135]
    v_exp_f32 v80, v80
    v_mfma_f32_16x16x32_bf16 v[136:139], v[64:67], a[136:139], v[136:139]
    ds_read_b128 a[116:119], v1 offset:29184
    ds_read_b128 a[120:123], v1 offset:29696
    v_mfma_f32_16x16x32_bf16 v[140:143], v[64:67], a[140:143], v[140:143]
    ds_read_b128 a[124:127], v1 offset:30208
    ds_read_b128 a[160:163], v2 offset:16384
    ds_read_b128 a[164:167], v2 offset:17408
    ds_read_b128 a[168:171], v2 offset:18432
    ds_read_b128 a[172:175], v2 offset:19456
    ds_read_b128 a[176:179], v2 offset:20480
    ds_read_b128 a[180:183], v2 offset:21504
    ds_read_b128 a[184:187], v2 offset:22528
    ds_read_b128 a[188:191], v2 offset:23552
    v_mfma_f32_16x16x32_bf16 v[144:147], v[64:67], a[144:147], v[144:147]
    v_exp_f32 v81, v81
    v_mfma_f32_16x16x32_bf16 v[148:151], v[64:67], a[148:151], v[148:151]
    v_exp_f32 v82, v82
    v_mfma_f32_16x16x32_bf16 v[152:155], v[64:67], a[152:155], v[152:155]
    v_exp_f32 v83, v83
    v_mfma_f32_16x16x32_bf16 v[156:159], v[64:67], a[156:159], v[156:159]
    v_exp_f32 v84, v84
    v_mfma_f32_16x16x32_bf16 v[112:115], v[64:67], a[192:195], v[112:115]
    v_exp_f32 v85, v85
    s_waitcnt lgkmcnt(8)
    v_mfma_f32_16x16x32_bf16 v[88:91], a[96:99], a[16:19], 0
    s_waitcnt vmcnt(12)
    v_exp_f32 v86, v86
    v_mfma_f32_16x16x32_bf16 v[88:91], a[100:103], a[20:23], v[88:91]
    v_exp_f32 v87, v87
    v_cvt_pk_bf16_f32 v64, v80, v81
    v_mfma_f32_16x16x32_bf16 v[88:91], a[104:107], a[24:27], v[88:91]
    v_cvt_pk_bf16_f32 v65, v82, v83
    v_cvt_pk_bf16_f32 v66, v84, v85
    v_cvt_pk_bf16_f32 v67, v86, v87
    v_mfma_f32_16x16x32_bf16 v[88:91], a[108:111], a[28:31], v[88:91]
    buffer_load_dwordx4 v[232:235], v4, s[16:19], s8 offen offset:0 nt
    v_mfma_f32_16x16x32_bf16 v[92:95], a[112:115], a[16:19], 0
    buffer_load_dwordx4 v[236:239], v4, s[16:19], s8 offen offset:128 nt
    v_mfma_f32_16x16x32_bf16 v[92:95], a[116:119], a[20:23], v[92:95]
    s_add_u32 s8, s8, 0x2000
    v_lshlrev_b32 v8, 16, v192
    v_and_b32 v9, s6, v192
    v_lshlrev_b32 v10, 16, v193
    v_mfma_f32_16x16x32_bf16 v[92:95], a[120:123], a[24:27], v[92:95]
    v_and_b32 v11, s6, v193
    v_lshlrev_b32 v12, 16, v194
    v_and_b32 v13, s6, v194
    v_mfma_f32_16x16x32_bf16 v[92:95], a[124:127], a[28:31], v[92:95]
    s_waitcnt lgkmcnt(0)
    v_lshlrev_b32 v14, 16, v195
    v_and_b32 v15, s6, v195
    v_mul_f32 v8, s7, v8
    v_mfma_f32_16x16x32_bf16 v[160:163], v[68:71], a[160:163], 0
    v_mul_f32 v9, s7, v9
    v_mul_f32 v10, s7, v10
    v_mul_f32 v11, s7, v11
    v_mfma_f32_16x16x32_bf16 v[164:167], v[68:71], a[164:167], 0
    v_mul_f32 v12, s7, v12
    v_mul_f32 v13, s7, v13
    v_mul_f32 v14, s7, v14
    v_mfma_f32_16x16x32_bf16 v[168:171], v[68:71], a[168:171], 0
    v_mul_f32 v15, s7, v15
    v_cvt_pk_bf16_f32 v192, v8, v9
    v_cvt_pk_bf16_f32 v193, v10, v11
    v_mfma_f32_16x16x32_bf16 v[172:175], v[68:71], a[172:175], 0
    v_cvt_pk_bf16_f32 v194, v12, v13
    v_cvt_pk_bf16_f32 v195, v14, v15
    v_mfma_f32_16x16x32_bf16 v[176:179], v[68:71], a[176:179], 0
    ds_write_b128 v6, v[192:195] offset:32768
    v_lshlrev_b32 v16, 16, v196
    v_mfma_f32_16x16x32_bf16 v[180:183], v[68:71], a[180:183], 0
    v_and_b32 v17, s6, v196
    v_lshlrev_b32 v18, 16, v197
    v_and_b32 v19, s6, v197
    v_lshlrev_b32 v20, 16, v198
    v_and_b32 v21, s6, v198
    v_lshlrev_b32 v22, 16, v199
    v_and_b32 v23, s6, v199
    v_mul_f32 v16, s7, v16
    v_mul_f32 v17, s7, v17
    v_mul_f32 v18, s7, v18
    v_mul_f32 v19, s7, v19
    v_mul_f32 v20, s7, v20
    v_mul_f32 v21, s7, v21
    v_mul_f32 v22, s7, v22
    v_mul_f32 v23, s7, v23
    v_cvt_pk_bf16_f32 v196, v16, v17
    v_cvt_pk_bf16_f32 v197, v18, v19
    v_cvt_pk_bf16_f32 v198, v20, v21
    v_cvt_pk_bf16_f32 v199, v22, v23
    ds_write_b128 v6, v[196:199] offset:33792
    s_waitcnt lgkmcnt(0)
    s_barrier
    v_mfma_f32_16x16x32_bf16 v[184:187], v[68:71], a[184:187], 0
    ds_read_b128 a[64:67], v1 offset:32768
    v_exp_f32 v88, v88
    v_mfma_f32_16x16x32_bf16 v[188:191], v[68:71], a[188:191], 0
    v_exp_f32 v89, v89
    v_mfma_f32_16x16x32_bf16 v[116:119], v[68:71], a[192:195], 0
    ds_read_b128 a[68:71], v1 offset:33280
    v_exp_f32 v90, v90
    v_mfma_f32_16x16x32_bf16 v[80:83], a[96:99], a[0:3], 0
    v_exp_f32 v91, v91
    v_mfma_f32_16x16x32_bf16 v[80:83], a[100:103], a[4:7], v[80:83]
    ds_read_b128 a[72:75], v1 offset:33792
    v_exp_f32 v92, v92
    v_mfma_f32_16x16x32_bf16 v[80:83], a[104:107], a[8:11], v[80:83]
    v_exp_f32 v93, v93
    v_mfma_f32_16x16x32_bf16 v[80:83], a[108:111], a[12:15], v[80:83]
    ds_read_b128 a[76:79], v1 offset:34304
    v_exp_f32 v94, v94
    v_mfma_f32_16x16x32_bf16 v[84:87], a[112:115], a[0:3], 0
    v_exp_f32 v95, v95
    v_cvt_pk_bf16_f32 v68, v88, v89
    v_mfma_f32_16x16x32_bf16 v[84:87], a[116:119], a[4:7], v[84:87]
    ds_read_b128 a[80:83], v1 offset:36864
    ds_read_b128 a[84:87], v1 offset:37376
    v_cvt_pk_bf16_f32 v69, v90, v91
    v_mfma_f32_16x16x32_bf16 v[84:87], a[120:123], a[8:11], v[84:87]
    v_cvt_pk_bf16_f32 v70, v92, v93
    v_cvt_pk_bf16_f32 v71, v94, v95
    v_mfma_f32_16x16x32_bf16 v[84:87], a[124:127], a[12:15], v[84:87]
    ds_read_b128 a[88:91], v1 offset:37888
    ds_read_b128 a[92:95], v1 offset:38400
    v_mfma_f32_16x16x32_bf16 v[128:131], v[64:67], a[160:163], v[128:131]
    buffer_load_dwordx4 v4, s[12:15], s28 offen offset:0 nt lds
    v_mfma_f32_16x16x32_bf16 v[132:135], v[64:67], a[164:167], v[132:135]
    ds_read_b128 a[128:131], v2 offset:24576
    ds_read_b128 a[132:135], v2 offset:25600
    v_mfma_f32_16x16x32_bf16 v[136:139], v[64:67], a[168:171], v[136:139]
    buffer_load_dwordx4 v4, s[12:15], s28 offen offset:2048 nt lds
    v_mfma_f32_16x16x32_bf16 v[140:143], v[64:67], a[172:175], v[140:143]
    ds_read_b128 a[136:139], v2 offset:26624
    ds_read_b128 a[140:143], v2 offset:27648
    ds_read_b128 a[144:147], v2 offset:28672
    ds_read_b128 a[148:151], v2 offset:29696
    ds_read_b128 a[152:155], v2 offset:30720
    ds_read_b128 a[156:159], v2 offset:31744
    v_mfma_f32_16x16x32_bf16 v[144:147], v[64:67], a[176:179], v[144:147]
    s_add_u32 m0, s31, 5120
    v_exp_f32 v80, v80
    v_mfma_f32_16x16x32_bf16 v[148:151], v[64:67], a[180:183], v[148:151]
    s_waitcnt vmcnt(10)
    ds_read_b128 a[32:35], v3 offset:0
    ds_read_b128 a[36:39], v3 offset:512
    ds_read_b128 a[40:43], v3 offset:1024
    ds_read_b128 a[44:47], v3 offset:1536
    v_mfma_f32_16x16x32_bf16 v[152:155], v[64:67], a[184:187], v[152:155]
    buffer_load_dwordx4 v4, s[12:15], s29 offen offset:0 nt lds
    v_mfma_f32_16x16x32_bf16 v[156:159], v[64:67], a[188:191], v[156:159]
    buffer_load_dwordx4 v4, s[12:15], s29 offen offset:2048 nt lds
    v_mfma_f32_16x16x32_bf16 v[112:115], v[64:67], a[192:195], v[112:115]
    s_add_u32 s28, s28, 0x4000
    s_add_u32 s29, s29, 0x4000
    v_exp_f32 v81, v81
    s_waitcnt lgkmcnt(0)
    v_mfma_f32_16x16x32_bf16 v[96:99], a[64:67], a[32:35], 0
    s_waitcnt vmcnt(8)
    v_exp_f32 v82, v82
    v_mfma_f32_16x16x32_bf16 v[96:99], a[68:71], a[36:39], v[96:99]
    s_add_u32 m0, s31, 0
    v_exp_f32 v83, v83
    v_mfma_f32_16x16x32_bf16 v[96:99], a[72:75], a[40:43], v[96:99]
    v_exp_f32 v84, v84
    v_mfma_f32_16x16x32_bf16 v[96:99], a[76:79], a[44:47], v[96:99]
    v_exp_f32 v85, v85
    v_mfma_f32_16x16x32_bf16 v[100:103], a[80:83], a[32:35], 0
    v_exp_f32 v86, v86
    v_mfma_f32_16x16x32_bf16 v[100:103], a[84:87], a[36:39], v[100:103]
    v_exp_f32 v87, v87
    v_cvt_pk_bf16_f32 v64, v80, v81
    v_mfma_f32_16x16x32_bf16 v[100:103], a[88:91], a[40:43], v[100:103]
    v_cvt_pk_bf16_f32 v65, v82, v83
    v_cvt_pk_bf16_f32 v66, v84, v85
    v_cvt_pk_bf16_f32 v67, v86, v87
    v_mfma_f32_16x16x32_bf16 v[100:103], a[92:95], a[44:47], v[100:103]
    v_exp_f32 v96, v96
    v_mfma_f32_16x16x32_bf16 v[80:83], a[64:67], a[0:3], 0
    v_exp_f32 v97, v97
    v_mfma_f32_16x16x32_bf16 v[80:83], a[68:71], a[4:7], v[80:83]
    v_exp_f32 v98, v98
    v_mfma_f32_16x16x32_bf16 v[80:83], a[72:75], a[8:11], v[80:83]
    v_exp_f32 v99, v99
    v_mfma_f32_16x16x32_bf16 v[80:83], a[76:79], a[12:15], v[80:83]
    v_exp_f32 v100, v100
    v_mfma_f32_16x16x32_bf16 v[84:87], a[80:83], a[0:3], 0
    v_exp_f32 v101, v101
    v_mfma_f32_16x16x32_bf16 v[84:87], a[84:87], a[4:7], v[84:87]
    v_exp_f32 v102, v102
    v_exp_f32 v103, v103
    v_mfma_f32_16x16x32_bf16 v[84:87], a[88:91], a[8:11], v[84:87]
    buffer_load_dwordx4 v[48:51], v5, s[20:23], s9 offen offset:0 nt
    v_cvt_pk_bf16_f32 v72, v96, v97
    v_mfma_f32_16x16x32_bf16 v[84:87], a[92:95], a[12:15], v[84:87]
    buffer_load_dwordx4 v[52:55], v5, s[20:23], s9 offen offset:256 nt
    v_cvt_pk_bf16_f32 v73, v98, v99
    v_mfma_f32_16x16x32_bf16 v[128:131], v[64:67], a[128:131], v[128:131]
    buffer_load_dwordx4 v[56:59], v5, s[20:23], s9 offen offset:512 nt
    v_cvt_pk_bf16_f32 v74, v100, v101
    v_mfma_f32_16x16x32_bf16 v[132:135], v[64:67], a[132:135], v[132:135]
    buffer_load_dwordx4 v[60:63], v5, s[20:23], s9 offen offset:768 nt
    s_add_u32 s9, s9, 0x4000
    v_perm_b32 v8, v244, v240, s4
    v_perm_b32 v9, v252, v248, s4
    ds_write_b64 v7, v[8:9] offset:32768
    v_perm_b32 v10, v244, v240, s5
    v_perm_b32 v11, v252, v248, s5
    ds_write_b64 v7, v[10:11] offset:33792
    v_perm_b32 v12, v245, v241, s4
    v_perm_b32 v13, v253, v249, s4
    ds_write_b64 v7, v[12:13] offset:34816
    v_perm_b32 v14, v245, v241, s5
    v_perm_b32 v15, v253, v249, s5
    ds_write_b64 v7, v[14:15] offset:35840
    v_perm_b32 v16, v246, v242, s4
    v_perm_b32 v17, v254, v250, s4
    ds_write_b64 v7, v[16:17] offset:36864
    v_perm_b32 v18, v246, v242, s5
    v_perm_b32 v19, v254, v250, s5
    ds_write_b64 v7, v[18:19] offset:37888
    v_perm_b32 v20, v247, v243, s4
    v_perm_b32 v21, v255, v251, s4
    ds_write_b64 v7, v[20:21] offset:38912
    v_perm_b32 v22, v247, v243, s5
    v_perm_b32 v23, v255, v251, s5
    ds_write_b64 v7, v[22:23] offset:39936
    v_lshlrev_b32 v8, 16, v200
    v_and_b32 v9, s6, v200
    v_lshlrev_b32 v10, 16, v201
    v_and_b32 v11, s6, v201
    v_lshlrev_b32 v12, 16, v202
    v_and_b32 v13, s6, v202
    v_lshlrev_b32 v14, 16, v203
    v_and_b32 v15, s6, v203
    v_mul_f32 v8, s7, v8
    v_mul_f32 v9, s7, v9
    v_mul_f32 v10, s7, v10
    v_mul_f32 v11, s7, v11
    v_mul_f32 v12, s7, v12
    v_mul_f32 v13, s7, v13
    v_mul_f32 v14, s7, v14
    v_mul_f32 v15, s7, v15
    v_cvt_pk_bf16_f32 v200, v8, v9
    v_cvt_pk_bf16_f32 v201, v10, v11
    v_cvt_pk_bf16_f32 v202, v12, v13
    v_cvt_pk_bf16_f32 v203, v14, v15
    ds_write_b128 v6, v[200:203] offset:40960
    v_lshlrev_b32 v16, 16, v204
    v_and_b32 v17, s6, v204
    v_lshlrev_b32 v18, 16, v205
    v_and_b32 v19, s6, v205
    v_lshlrev_b32 v20, 16, v206
    v_and_b32 v21, s6, v206
    v_lshlrev_b32 v22, 16, v207
    v_and_b32 v23, s6, v207
    v_mul_f32 v16, s7, v16
    v_mul_f32 v17, s7, v17
    v_mul_f32 v18, s7, v18
    v_mul_f32 v19, s7, v19
    v_mul_f32 v20, s7, v20
    v_mul_f32 v21, s7, v21
    v_mul_f32 v22, s7, v22
    v_mul_f32 v23, s7, v23
    v_cvt_pk_bf16_f32 v204, v16, v17
    v_cvt_pk_bf16_f32 v205, v18, v19
    v_cvt_pk_bf16_f32 v206, v20, v21
    v_cvt_pk_bf16_f32 v207, v22, v23
    ds_write_b128 v6, v[204:207] offset:41984
    s_waitcnt lgkmcnt(0)
    s_barrier
    v_mfma_f32_16x16x32_bf16 v[136:139], v[64:67], a[136:139], v[136:139]
    ds_read_b128 a[96:99], v1 offset:40960
    v_cvt_pk_bf16_f32 v75, v102, v103
    v_mfma_f32_16x16x32_bf16 v[140:143], v[64:67], a[140:143], v[140:143]
    v_exp_f32 v80, v80
    v_mfma_f32_16x16x32_bf16 v[144:147], v[64:67], a[144:147], v[144:147]
    v_exp_f32 v81, v81
    v_mfma_f32_16x16x32_bf16 v[148:151], v[64:67], a[148:151], v[148:151]
    v_exp_f32 v82, v82
    v_mfma_f32_16x16x32_bf16 v[152:155], v[64:67], a[152:155], v[152:155]
    ds_read_b128 a[100:103], v1 offset:41472
    v_exp_f32 v83, v83
    v_mfma_f32_16x16x32_bf16 v[156:159], v[64:67], a[156:159], v[156:159]
    v_exp_f32 v84, v84
    v_mfma_f32_16x16x32_bf16 v[112:115], v[64:67], a[192:195], v[112:115]
    ds_read_b128 a[104:107], v1 offset:41984
    v_exp_f32 v85, v85
    v_mfma_f32_16x16x32_bf16 v[88:91], a[64:67], a[16:19], 0
    v_exp_f32 v86, v86
    v_mfma_f32_16x16x32_bf16 v[88:91], a[68:71], a[20:23], v[88:91]
    ds_read_b128 a[108:111], v1 offset:42496
    v_exp_f32 v87, v87
    v_mfma_f32_16x16x32_bf16 v[88:91], a[72:75], a[24:27], v[88:91]
    v_cvt_pk_bf16_f32 v64, v80, v81
    v_cvt_pk_bf16_f32 v65, v82, v83
    v_cvt_pk_bf16_f32 v66, v84, v85
    v_mfma_f32_16x16x32_bf16 v[88:91], a[76:79], a[28:31], v[88:91]
    ds_read_b128 a[112:115], v1 offset:45056
    ds_read_b128 a[116:119], v1 offset:45568
    v_cvt_pk_bf16_f32 v67, v86, v87
    v_mfma_f32_16x16x32_bf16 v[92:95], a[80:83], a[16:19], 0
    buffer_load_dwordx4 v4, s[12:15], s28 offen offset:0 nt lds
    v_mfma_f32_16x16x32_bf16 v[92:95], a[84:87], a[20:23], v[92:95]
    ds_read_b128 a[120:123], v1 offset:46080
    ds_read_b128 a[124:127], v1 offset:46592
    v_mfma_f32_16x16x32_bf16 v[92:95], a[88:91], a[24:27], v[92:95]
    buffer_load_dwordx4 v4, s[12:15], s28 offen offset:2048 nt lds
    v_mfma_f32_16x16x32_bf16 v[92:95], a[92:95], a[28:31], v[92:95]
    s_add_u32 m0, s31, 1024
    ds_read_b128 a[160:163], v2 offset:32768
    ds_read_b128 a[164:167], v2 offset:33792
    v_mfma_f32_16x16x32_bf16 v[160:163], v[68:71], a[128:131], v[160:163]
    v_exp_f32 v88, v88
    v_mfma_f32_16x16x32_bf16 v[164:167], v[68:71], a[132:135], v[164:167]
    ds_read_b128 a[168:171], v2 offset:34816
    ds_read_b128 a[172:175], v2 offset:35840
    v_mfma_f32_16x16x32_bf16 v[168:171], v[68:71], a[136:139], v[168:171]
    v_exp_f32 v89, v89
    v_mfma_f32_16x16x32_bf16 v[172:175], v[68:71], a[140:143], v[172:175]
    ds_read_b128 a[176:179], v2 offset:36864
    ds_read_b128 a[180:183], v2 offset:37888
    ds_read_b128 a[184:187], v2 offset:38912
    ds_read_b128 a[188:191], v2 offset:39936
    v_mfma_f32_16x16x32_bf16 v[176:179], v[68:71], a[144:147], v[176:179]
    v_exp_f32 v90, v90
    v_mfma_f32_16x16x32_bf16 v[180:183], v[68:71], a[148:151], v[180:183]
    v_exp_f32 v91, v91
    v_mfma_f32_16x16x32_bf16 v[184:187], v[68:71], a[152:155], v[184:187]
    v_exp_f32 v92, v92
    v_mfma_f32_16x16x32_bf16 v[188:191], v[68:71], a[156:159], v[188:191]
    v_exp_f32 v93, v93
    v_mfma_f32_16x16x32_bf16 v[116:119], v[68:71], a[192:195], v[116:119]
    v_exp_f32 v94, v94
    s_waitcnt lgkmcnt(8)
    v_mfma_f32_16x16x32_bf16 v[96:99], a[96:99], a[32:35], 0
    s_waitcnt vmcnt(12)
    v_exp_f32 v95, v95
    v_cvt_pk_bf16_f32 v68, v88, v89
    v_mfma_f32_16x16x32_bf16 v[96:99], a[100:103], a[36:39], v[96:99]
    v_cvt_pk_bf16_f32 v69, v90, v91
    v_cvt_pk_bf16_f32 v70, v92, v93
    v_cvt_pk_bf16_f32 v71, v94, v95
    v_mfma_f32_16x16x32_bf16 v[96:99], a[104:107], a[40:43], v[96:99]
    v_lshlrev_b32 v8, 16, v224
    v_and_b32 v9, s6, v224
    v_lshlrev_b32 v10, 16, v225
    v_mfma_f32_16x16x32_bf16 v[96:99], a[108:111], a[44:47], v[96:99]
    v_and_b32 v11, s6, v225
    v_lshlrev_b32 v12, 16, v226
    v_and_b32 v13, s6, v226
    v_mfma_f32_16x16x32_bf16 v[100:103], a[112:115], a[32:35], 0
    v_lshlrev_b32 v14, 16, v227
    v_and_b32 v15, s6, v227
    v_mul_f32 v8, s7, v8
    v_mfma_f32_16x16x32_bf16 v[100:103], a[116:119], a[36:39], v[100:103]
    v_mul_f32 v9, s7, v9
    v_mul_f32 v10, s7, v10
    v_mul_f32 v11, s7, v11
    v_mfma_f32_16x16x32_bf16 v[100:103], a[120:123], a[40:43], v[100:103]
    v_mul_f32 v12, s7, v12
    v_mul_f32 v13, s7, v13
    v_mul_f32 v14, s7, v14
    v_mfma_f32_16x16x32_bf16 v[100:103], a[124:127], a[44:47], v[100:103]
    s_waitcnt lgkmcnt(0)
    v_mul_f32 v15, s7, v15
    v_cvt_pk_bf16_f32 v224, v8, v9
    v_cvt_pk_bf16_f32 v225, v10, v11
    v_mfma_f32_16x16x32_bf16 v[192:195], v[72:75], a[160:163], 0
    v_cvt_pk_bf16_f32 v226, v12, v13
    v_cvt_pk_bf16_f32 v227, v14, v15
    v_mfma_f32_16x16x32_bf16 v[196:199], v[72:75], a[164:167], 0
    ds_write_b128 v6, v[224:227] offset:49152
    v_lshlrev_b32 v16, 16, v228
    v_mfma_f32_16x16x32_bf16 v[200:203], v[72:75], a[168:171], 0
    v_and_b32 v17, s6, v228
    v_lshlrev_b32 v18, 16, v229
    v_and_b32 v19, s6, v229
    v_mfma_f32_16x16x32_bf16 v[204:207], v[72:75], a[172:175], 0
    v_lshlrev_b32 v20, 16, v230
    v_and_b32 v21, s6, v230
    v_lshlrev_b32 v22, 16, v231
    v_mfma_f32_16x16x32_bf16 v[208:211], v[72:75], a[176:179], 0
    v_and_b32 v23, s6, v231
    v_mul_f32 v16, s7, v16
    v_mul_f32 v17, s7, v17
    v_mfma_f32_16x16x32_bf16 v[212:215], v[72:75], a[180:183], 0
    v_mul_f32 v18, s7, v18
    v_mul_f32 v19, s7, v19
    v_mul_f32 v20, s7, v20
    v_mfma_f32_16x16x32_bf16 v[216:219], v[72:75], a[184:187], 0
    v_mul_f32 v21, s7, v21
    v_mul_f32 v22, s7, v22
    v_mul_f32 v23, s7, v23
    v_mfma_f32_16x16x32_bf16 v[220:223], v[72:75], a[188:191], 0
    v_cvt_pk_bf16_f32 v228, v16, v17
    v_cvt_pk_bf16_f32 v229, v18, v19
    v_cvt_pk_bf16_f32 v230, v20, v21
    v_mfma_f32_16x16x32_bf16 v[120:123], v[72:75], a[192:195], 0
    v_cvt_pk_bf16_f32 v231, v22, v23
    v_exp_f32 v96, v96
    v_mfma_f32_16x16x32_bf16 v[80:83], a[96:99], a[0:3], 0
    ds_write_b128 v6, v[228:231] offset:50176
    v_mfma_f32_16x16x32_bf16 v[80:83], a[100:103], a[4:7], v[80:83]
    v_exp_f32 v97, v97
    v_mfma_f32_16x16x32_bf16 v[80:83], a[104:107], a[8:11], v[80:83]
    v_exp_f32 v98, v98
    v_mfma_f32_16x16x32_bf16 v[80:83], a[108:111], a[12:15], v[80:83]
    v_exp_f32 v99, v99
    s_waitcnt lgkmcnt(0)
    s_barrier
    v_mfma_f32_16x16x32_bf16 v[84:87], a[112:115], a[0:3], 0
    ds_read_b128 a[64:67], v1 offset:49152
    v_exp_f32 v100, v100
    v_mfma_f32_16x16x32_bf16 v[84:87], a[116:119], a[4:7], v[84:87]
    v_exp_f32 v101, v101
    v_exp_f32 v102, v102
    v_exp_f32 v103, v103
    v_mfma_f32_16x16x32_bf16 v[84:87], a[120:123], a[8:11], v[84:87]
    v_cvt_pk_bf16_f32 v72, v96, v97
    v_cvt_pk_bf16_f32 v73, v98, v99
    v_mfma_f32_16x16x32_bf16 v[84:87], a[124:127], a[12:15], v[84:87]
    ds_read_b128 a[68:71], v1 offset:49664
    v_cvt_pk_bf16_f32 v74, v100, v101
    v_cvt_pk_bf16_f32 v75, v102, v103
    v_mfma_f32_16x16x32_bf16 v[128:131], v[64:67], a[160:163], v[128:131]
    v_exp_f32 v80, v80
    v_mfma_f32_16x16x32_bf16 v[132:135], v[64:67], a[164:167], v[132:135]
    ds_read_b128 a[72:75], v1 offset:50176
    v_exp_f32 v81, v81
    v_mfma_f32_16x16x32_bf16 v[136:139], v[64:67], a[168:171], v[136:139]
    v_exp_f32 v82, v82
    v_mfma_f32_16x16x32_bf16 v[140:143], v[64:67], a[172:175], v[140:143]
    v_exp_f32 v83, v83
    v_mfma_f32_16x16x32_bf16 v[144:147], v[64:67], a[176:179], v[144:147]
    v_exp_f32 v84, v84
    v_mfma_f32_16x16x32_bf16 v[148:151], v[64:67], a[180:183], v[148:151]
    v_exp_f32 v85, v85
    v_mfma_f32_16x16x32_bf16 v[152:155], v[64:67], a[184:187], v[152:155]
    v_exp_f32 v86, v86
    v_mfma_f32_16x16x32_bf16 v[156:159], v[64:67], a[188:191], v[156:159]
    v_exp_f32 v87, v87
    v_mfma_f32_16x16x32_bf16 v[112:115], v[64:67], a[192:195], v[112:115]
    ds_read_b128 a[76:79], v1 offset:50688
    ds_read_b128 a[80:83], v1 offset:53248
    v_mfma_f32_16x16x32_bf16 v[88:91], a[96:99], a[16:19], 0
    v_cvt_pk_bf16_f32 v64, v80, v81
    v_cvt_pk_bf16_f32 v65, v82, v83
    v_mfma_f32_16x16x32_bf16 v[88:91], a[100:103], a[20:23], v[88:91]
    ds_read_b128 a[84:87], v1 offset:53760
    ds_read_b128 a[88:91], v1 offset:54272
    v_cvt_pk_bf16_f32 v66, v84, v85
    v_mfma_f32_16x16x32_bf16 v[88:91], a[104:107], a[24:27], v[88:91]
    buffer_load_dwordx4 v4, s[12:15], s29 offen offset:0 nt lds
    v_cvt_pk_bf16_f32 v67, v86, v87
    v_mfma_f32_16x16x32_bf16 v[88:91], a[108:111], a[28:31], v[88:91]
    ds_read_b128 a[92:95], v1 offset:54784
    ds_read_b128 a[128:131], v2 offset:40960
    v_mfma_f32_16x16x32_bf16 v[92:95], a[112:115], a[16:19], 0
    buffer_load_dwordx4 v4, s[12:15], s29 offen offset:2048 nt lds
    v_mfma_f32_16x16x32_bf16 v[92:95], a[116:119], a[20:23], v[92:95]
    s_add_u32 s28, s28, 0x4000
    s_add_u32 s29, s29, 0x4000
    ds_read_b128 a[132:135], v2 offset:41984
    ds_read_b128 a[136:139], v2 offset:43008
    v_mfma_f32_16x16x32_bf16 v[92:95], a[120:123], a[24:27], v[92:95]
    v_mfma_f32_16x16x32_bf16 v[92:95], a[124:127], a[28:31], v[92:95]
    ds_read_b128 a[140:143], v2 offset:44032
    ds_read_b128 a[144:147], v2 offset:45056
    v_mfma_f32_16x16x32_bf16 v[160:163], v[68:71], a[160:163], v[160:163]
    v_exp_f32 v88, v88
    v_mfma_f32_16x16x32_bf16 v[164:167], v[68:71], a[164:167], v[164:167]
    ds_read_b128 a[148:151], v2 offset:46080
    ds_read_b128 a[152:155], v2 offset:47104
    v_mfma_f32_16x16x32_bf16 v[168:171], v[68:71], a[168:171], v[168:171]
    v_exp_f32 v89, v89
    v_mfma_f32_16x16x32_bf16 v[172:175], v[68:71], a[172:175], v[172:175]
    ds_read_b128 a[156:159], v2 offset:48128
    s_waitcnt vmcnt(8)
    ds_read_b128 a[48:51], v3 offset:4096
    v_mfma_f32_16x16x32_bf16 v[176:179], v[68:71], a[176:179], v[176:179]
    v_exp_f32 v90, v90
    v_mfma_f32_16x16x32_bf16 v[180:183], v[68:71], a[180:183], v[180:183]
    ds_read_b128 a[52:55], v3 offset:4608
    ds_read_b128 a[56:59], v3 offset:5120
    ds_read_b128 a[60:63], v3 offset:5632
    v_mfma_f32_16x16x32_bf16 v[184:187], v[68:71], a[184:187], v[184:187]
    v_exp_f32 v91, v91
    v_mfma_f32_16x16x32_bf16 v[188:191], v[68:71], a[188:191], v[188:191]
    v_exp_f32 v92, v92
    v_mfma_f32_16x16x32_bf16 v[116:119], v[68:71], a[192:195], v[116:119]
    v_exp_f32 v93, v93
    s_waitcnt lgkmcnt(0)
    v_mfma_f32_16x16x32_bf16 v[104:107], a[64:67], a[48:51], 0
    s_waitcnt vmcnt(4)
    v_exp_f32 v94, v94
    v_perm_b32 v8, v52, v48, s4
    v_mfma_f32_16x16x32_bf16 v[104:107], a[68:71], a[52:55], v[104:107]
    s_add_u32 m0, s31, 4096
    v_exp_f32 v95, v95
    v_cvt_pk_bf16_f32 v68, v88, v89
    v_mfma_f32_16x16x32_bf16 v[104:107], a[72:75], a[56:59], v[104:107]
    v_cvt_pk_bf16_f32 v69, v90, v91
    v_cvt_pk_bf16_f32 v70, v92, v93
    v_cvt_pk_bf16_f32 v71, v94, v95
    v_mfma_f32_16x16x32_bf16 v[104:107], a[76:79], a[60:63], v[104:107]
    buffer_load_dwordx4 v4, s[12:15], s28 offen offset:0 nt lds
    v_perm_b32 v9, v60, v56, s4
    v_mfma_f32_16x16x32_bf16 v[108:111], a[80:83], a[48:51], 0
    ds_write_b64 v7, v[8:9] offset:49152
    v_perm_b32 v10, v52, v48, s5
    v_mfma_f32_16x16x32_bf16 v[108:111], a[84:87], a[52:55], v[108:111]
    buffer_load_dwordx4 v4, s[12:15], s28 offen offset:2048 nt lds
    v_perm_b32 v11, v60, v56, s5
    v_mfma_f32_16x16x32_bf16 v[108:111], a[88:91], a[56:59], v[108:111]
    s_add_u32 m0, s31, 5120
    ds_write_b64 v7, v[10:11] offset:50176
    v_perm_b32 v12, v53, v49, s4
    v_mfma_f32_16x16x32_bf16 v[108:111], a[92:95], a[60:63], v[108:111]
    v_exp_f32 v104, v104
    v_perm_b32 v13, v61, v57, s4
    v_mfma_f32_16x16x32_bf16 v[80:83], a[64:67], a[0:3], 0
    v_exp_f32 v105, v105
    v_mfma_f32_16x16x32_bf16 v[80:83], a[68:71], a[4:7], v[80:83]
    v_exp_f32 v106, v106
    v_mfma_f32_16x16x32_bf16 v[80:83], a[72:75], a[8:11], v[80:83]
    v_exp_f32 v107, v107
    v_mfma_f32_16x16x32_bf16 v[80:83], a[76:79], a[12:15], v[80:83]
    v_exp_f32 v108, v108
    v_mfma_f32_16x16x32_bf16 v[84:87], a[80:83], a[0:3], 0
    v_exp_f32 v109, v109
    v_mfma_f32_16x16x32_bf16 v[84:87], a[84:87], a[4:7], v[84:87]
    v_exp_f32 v110, v110
    v_exp_f32 v111, v111
    v_mfma_f32_16x16x32_bf16 v[84:87], a[88:91], a[8:11], v[84:87]
    v_cvt_pk_bf16_f32 v76, v104, v105
    v_cvt_pk_bf16_f32 v77, v106, v107
    v_cvt_pk_bf16_f32 v78, v108, v109
    v_mfma_f32_16x16x32_bf16 v[84:87], a[92:95], a[12:15], v[84:87]
    ds_write_b64 v7, v[12:13] offset:51200
    v_cvt_pk_bf16_f32 v79, v110, v111
    v_mfma_f32_16x16x32_bf16 v[128:131], v[64:67], a[128:131], v[128:131]
    v_perm_b32 v14, v53, v49, s5
    v_perm_b32 v15, v61, v57, s5
    v_mfma_f32_16x16x32_bf16 v[132:135], v[64:67], a[132:135], v[132:135]
    ds_write_b64 v7, v[14:15] offset:52224
    v_perm_b32 v16, v54, v50, s4
    v_mfma_f32_16x16x32_bf16 v[136:139], v[64:67], a[136:139], v[136:139]
    v_perm_b32 v17, v62, v58, s4
    v_exp_f32 v80, v80
    v_mfma_f32_16x16x32_bf16 v[140:143], v[64:67], a[140:143], v[140:143]
    ds_write_b64 v7, v[16:17] offset:53248
    v_perm_b32 v18, v54, v50, s5
    v_mfma_f32_16x16x32_bf16 v[144:147], v[64:67], a[144:147], v[144:147]
    v_perm_b32 v19, v62, v58, s5
    v_exp_f32 v81, v81
    v_mfma_f32_16x16x32_bf16 v[148:151], v[64:67], a[148:151], v[148:151]
    ds_write_b64 v7, v[18:19] offset:54272
    v_perm_b32 v20, v55, v51, s4
    v_mfma_f32_16x16x32_bf16 v[152:155], v[64:67], a[152:155], v[152:155]
    v_perm_b32 v21, v63, v59, s4
    v_exp_f32 v82, v82
    v_mfma_f32_16x16x32_bf16 v[156:159], v[64:67], a[156:159], v[156:159]
    ds_write_b64 v7, v[20:21] offset:55296
    v_perm_b32 v22, v55, v51, s5
    v_mfma_f32_16x16x32_bf16 v[112:115], v[64:67], a[192:195], v[112:115]
    v_perm_b32 v23, v63, v59, s5
    ds_write_b64 v7, v[22:23] offset:56320
    v_lshlrev_b32 v8, 16, v232
    v_and_b32 v9, s6, v232
    v_lshlrev_b32 v10, 16, v233
    v_and_b32 v11, s6, v233
    v_lshlrev_b32 v12, 16, v234
    v_and_b32 v13, s6, v234
    v_lshlrev_b32 v14, 16, v235
    v_and_b32 v15, s6, v235
    v_mul_f32 v8, s7, v8
    v_mul_f32 v9, s7, v9
    v_mul_f32 v10, s7, v10
    v_mul_f32 v11, s7, v11
    v_mul_f32 v12, s7, v12
    v_mul_f32 v13, s7, v13
    v_mul_f32 v14, s7, v14
    v_mul_f32 v15, s7, v15
    v_cvt_pk_bf16_f32 v232, v8, v9
    v_cvt_pk_bf16_f32 v233, v10, v11
    v_cvt_pk_bf16_f32 v234, v12, v13
    v_cvt_pk_bf16_f32 v235, v14, v15
    ds_write_b128 v6, v[232:235] offset:57344
    v_lshlrev_b32 v16, 16, v236
    v_and_b32 v17, s6, v236
    v_lshlrev_b32 v18, 16, v237
    v_and_b32 v19, s6, v237
    v_lshlrev_b32 v20, 16, v238
    v_and_b32 v21, s6, v238
    v_lshlrev_b32 v22, 16, v239
    v_and_b32 v23, s6, v239
    v_mul_f32 v16, s7, v16
    v_mul_f32 v17, s7, v17
    v_mul_f32 v18, s7, v18
    v_mul_f32 v19, s7, v19
    v_mul_f32 v20, s7, v20
    v_mul_f32 v21, s7, v21
    v_mul_f32 v22, s7, v22
    v_mul_f32 v23, s7, v23
    v_cvt_pk_bf16_f32 v236, v16, v17
    v_cvt_pk_bf16_f32 v237, v18, v19
    v_cvt_pk_bf16_f32 v238, v20, v21
    v_cvt_pk_bf16_f32 v239, v22, v23
    ds_write_b128 v6, v[236:239] offset:58368
    s_waitcnt lgkmcnt(0)
    s_barrier
    v_mfma_f32_16x16x32_bf16 v[88:91], a[64:67], a[16:19], 0
    v_exp_f32 v83, v83
    v_mfma_f32_16x16x32_bf16 v[88:91], a[68:71], a[20:23], v[88:91]
    v_exp_f32 v84, v84
    v_mfma_f32_16x16x32_bf16 v[88:91], a[72:75], a[24:27], v[88:91]
    v_exp_f32 v85, v85
    v_mfma_f32_16x16x32_bf16 v[88:91], a[76:79], a[28:31], v[88:91]
    v_exp_f32 v86, v86
    v_mfma_f32_16x16x32_bf16 v[92:95], a[80:83], a[16:19], 0
    v_exp_f32 v87, v87
    v_mfma_f32_16x16x32_bf16 v[92:95], a[84:87], a[20:23], v[92:95]
    v_cvt_pk_bf16_f32 v64, v80, v81
    v_cvt_pk_bf16_f32 v65, v82, v83
    v_mfma_f32_16x16x32_bf16 v[92:95], a[88:91], a[24:27], v[92:95]
    v_cvt_pk_bf16_f32 v66, v84, v85
    v_cvt_pk_bf16_f32 v67, v86, v87
    v_mfma_f32_16x16x32_bf16 v[92:95], a[92:95], a[28:31], v[92:95]
    v_exp_f32 v88, v88
    v_mfma_f32_16x16x32_bf16 v[160:163], v[68:71], a[128:131], v[160:163]
    v_exp_f32 v89, v89
    v_mfma_f32_16x16x32_bf16 v[164:167], v[68:71], a[132:135], v[164:167]
    v_exp_f32 v90, v90
    v_mfma_f32_16x16x32_bf16 v[168:171], v[68:71], a[136:139], v[168:171]
    v_exp_f32 v91, v91
    v_mfma_f32_16x16x32_bf16 v[172:175], v[68:71], a[140:143], v[172:175]
    v_exp_f32 v92, v92
    v_mfma_f32_16x16x32_bf16 v[176:179], v[68:71], a[144:147], v[176:179]
    v_exp_f32 v93, v93
    v_mfma_f32_16x16x32_bf16 v[180:183], v[68:71], a[148:151], v[180:183]
    v_exp_f32 v94, v94
    v_mfma_f32_16x16x32_bf16 v[184:187], v[68:71], a[152:155], v[184:187]
    v_exp_f32 v95, v95
    v_mfma_f32_16x16x32_bf16 v[188:191], v[68:71], a[156:159], v[188:191]
    ds_read_b128 a[96:99], v1 offset:57344
    ds_read_b128 a[100:103], v1 offset:57856
    v_mfma_f32_16x16x32_bf16 v[116:119], v[68:71], a[192:195], v[116:119]
    v_cvt_pk_bf16_f32 v68, v88, v89
    v_cvt_pk_bf16_f32 v69, v90, v91
    v_mfma_f32_16x16x32_bf16 v[96:99], a[64:67], a[32:35], 0
    ds_read_b128 a[104:107], v1 offset:58368
    ds_read_b128 a[108:111], v1 offset:58880
    v_mfma_f32_16x16x32_bf16 v[96:99], a[68:71], a[36:39], v[96:99]
    v_cvt_pk_bf16_f32 v70, v92, v93
    v_cvt_pk_bf16_f32 v71, v94, v95
    v_mfma_f32_16x16x32_bf16 v[96:99], a[72:75], a[40:43], v[96:99]
    ds_read_b128 a[112:115], v1 offset:61440
    ds_read_b128 a[116:119], v1 offset:61952
    v_mfma_f32_16x16x32_bf16 v[96:99], a[76:79], a[44:47], v[96:99]
    buffer_load_dwordx4 v4, s[12:15], s29 offen offset:0 nt lds
    v_mfma_f32_16x16x32_bf16 v[100:103], a[80:83], a[32:35], 0
    ds_read_b128 a[120:123], v1 offset:62464
    ds_read_b128 a[124:127], v1 offset:62976
    v_mfma_f32_16x16x32_bf16 v[100:103], a[84:87], a[36:39], v[100:103]
    buffer_load_dwordx4 v4, s[12:15], s29 offen offset:2048 nt lds
    v_mfma_f32_16x16x32_bf16 v[100:103], a[88:91], a[40:43], v[100:103]
    s_add_u32 s28, s28, 0x4000
    ds_read_b128 a[160:163], v2 offset:49152
    ds_read_b128 a[164:167], v2 offset:50176
    v_mfma_f32_16x16x32_bf16 v[100:103], a[92:95], a[44:47], v[100:103]
    s_add_u32 s29, s29, 0x4000
    v_exp_f32 v96, v96
    v_mfma_f32_16x16x32_bf16 v[192:195], v[72:75], a[128:131], v[192:195]
    ds_read_b128 a[168:171], v2 offset:51200
    ds_read_b128 a[172:175], v2 offset:52224
    v_mfma_f32_16x16x32_bf16 v[196:199], v[72:75], a[132:135], v[196:199]
    v_exp_f32 v97, v97
    v_mfma_f32_16x16x32_bf16 v[200:203], v[72:75], a[136:139], v[200:203]
    ds_read_b128 a[176:179], v2 offset:53248
    ds_read_b128 a[180:183], v2 offset:54272
    v_mfma_f32_16x16x32_bf16 v[204:207], v[72:75], a[140:143], v[204:207]
    ds_read_b128 a[184:187], v2 offset:55296
    ds_read_b128 a[188:191], v2 offset:56320
    v_mfma_f32_16x16x32_bf16 v[208:211], v[72:75], a[144:147], v[208:211]
    v_exp_f32 v98, v98
    v_mfma_f32_16x16x32_bf16 v[212:215], v[72:75], a[148:151], v[212:215]
    v_exp_f32 v99, v99
    v_mfma_f32_16x16x32_bf16 v[216:219], v[72:75], a[152:155], v[216:219]
    v_exp_f32 v100, v100
    v_mfma_f32_16x16x32_bf16 v[220:223], v[72:75], a[156:159], v[220:223]
    v_exp_f32 v101, v101
    v_mfma_f32_16x16x32_bf16 v[120:123], v[72:75], a[192:195], v[120:123]
    v_exp_f32 v102, v102
    s_waitcnt lgkmcnt(8)
    v_mfma_f32_16x16x32_bf16 v[104:107], a[96:99], a[48:51], 0
    v_exp_f32 v103, v103
    v_mfma_f32_16x16x32_bf16 v[104:107], a[100:103], a[52:55], v[104:107]
    v_cvt_pk_bf16_f32 v72, v96, v97
    v_cvt_pk_bf16_f32 v73, v98, v99
    v_mfma_f32_16x16x32_bf16 v[104:107], a[104:107], a[56:59], v[104:107]
    v_cvt_pk_bf16_f32 v74, v100, v101
    v_cvt_pk_bf16_f32 v75, v102, v103
    v_mfma_f32_16x16x32_bf16 v[104:107], a[108:111], a[60:63], v[104:107]
    ds_read_b128 a[64:67], v1 offset:0
    ds_read_b128 a[68:71], v1 offset:512
    v_mfma_f32_16x16x32_bf16 v[108:111], a[112:115], a[48:51], 0
    v_mfma_f32_16x16x32_bf16 v[108:111], a[116:119], a[52:55], v[108:111]
    ds_read_b128 a[72:75], v1 offset:1024
    ds_read_b128 a[76:79], v1 offset:1536
    v_mfma_f32_16x16x32_bf16 v[108:111], a[120:123], a[56:59], v[108:111]
    v_mfma_f32_16x16x32_bf16 v[108:111], a[124:127], a[60:63], v[108:111]
    s_waitcnt lgkmcnt(4)
    v_exp_f32 v104, v104
    v_mfma_f32_16x16x32_bf16 v[224:227], v[76:79], a[160:163], 0
    v_exp_f32 v105, v105
    v_mfma_f32_16x16x32_bf16 v[228:231], v[76:79], a[164:167], 0
    v_exp_f32 v106, v106
    v_mfma_f32_16x16x32_bf16 v[232:235], v[76:79], a[168:171], 0
    v_exp_f32 v107, v107
    v_mfma_f32_16x16x32_bf16 v[236:239], v[76:79], a[172:175], 0
    v_exp_f32 v108, v108
    v_mfma_f32_16x16x32_bf16 v[240:243], v[76:79], a[176:179], 0
    v_exp_f32 v109, v109
    v_mfma_f32_16x16x32_bf16 v[244:247], v[76:79], a[180:183], 0
    v_exp_f32 v110, v110
    v_mfma_f32_16x16x32_bf16 v[248:251], v[76:79], a[184:187], 0
    v_exp_f32 v111, v111
    v_mfma_f32_16x16x32_bf16 v[252:255], v[76:79], a[188:191], 0
    ds_read_b128 a[80:83], v1 offset:4096
    ds_read_b128 a[84:87], v1 offset:4608
    v_mfma_f32_16x16x32_bf16 v[124:127], v[76:79], a[192:195], 0
    v_cvt_pk_bf16_f32 v76, v104, v105
    v_cvt_pk_bf16_f32 v77, v106, v107
    v_mfma_f32_16x16x32_bf16 v[80:83], a[96:99], a[0:3], 0
    v_cvt_pk_bf16_f32 v78, v108, v109
    v_cvt_pk_bf16_f32 v79, v110, v111
    v_mfma_f32_16x16x32_bf16 v[80:83], a[100:103], a[4:7], v[80:83]
    ds_read_b128 a[88:91], v1 offset:5120
    ds_read_b128 a[92:95], v1 offset:5632
    v_mfma_f32_16x16x32_bf16 v[80:83], a[104:107], a[8:11], v[80:83]
    v_mfma_f32_16x16x32_bf16 v[80:83], a[108:111], a[12:15], v[80:83]
    ds_read_b128 a[128:131], v2 offset:57344
    ds_read_b128 a[132:135], v2 offset:58368
    v_mfma_f32_16x16x32_bf16 v[84:87], a[112:115], a[0:3], 0
    v_mfma_f32_16x16x32_bf16 v[84:87], a[116:119], a[4:7], v[84:87]
    ds_read_b128 a[136:139], v2 offset:59392
    ds_read_b128 a[140:143], v2 offset:60416
    v_mfma_f32_16x16x32_bf16 v[84:87], a[120:123], a[8:11], v[84:87]
    v_mfma_f32_16x16x32_bf16 v[84:87], a[124:127], a[12:15], v[84:87]
    v_exp_f32 v80, v80
    v_mfma_f32_16x16x32_bf16 v[128:131], v[64:67], a[160:163], v[128:131]
    v_exp_f32 v81, v81
    v_mfma_f32_16x16x32_bf16 v[132:135], v[64:67], a[164:167], v[132:135]
    v_exp_f32 v82, v82
    v_mfma_f32_16x16x32_bf16 v[136:139], v[64:67], a[168:171], v[136:139]
    v_exp_f32 v83, v83
    v_mfma_f32_16x16x32_bf16 v[140:143], v[64:67], a[172:175], v[140:143]
    v_exp_f32 v84, v84
    v_mfma_f32_16x16x32_bf16 v[144:147], v[64:67], a[176:179], v[144:147]
    v_exp_f32 v85, v85
    v_mfma_f32_16x16x32_bf16 v[148:151], v[64:67], a[180:183], v[148:151]
    v_exp_f32 v86, v86
    v_mfma_f32_16x16x32_bf16 v[152:155], v[64:67], a[184:187], v[152:155]
    v_exp_f32 v87, v87
    v_mfma_f32_16x16x32_bf16 v[156:159], v[64:67], a[188:191], v[156:159]
    s_waitcnt vmcnt(4)
    ds_read_b128 a[0:3], v3 offset:0
    ds_read_b128 a[4:7], v3 offset:512
    v_mfma_f32_16x16x32_bf16 v[112:115], v[64:67], a[192:195], v[112:115]
    v_cvt_pk_bf16_f32 v64, v80, v81
    v_cvt_pk_bf16_f32 v65, v82, v83
    v_mfma_f32_16x16x32_bf16 v[88:91], a[96:99], a[16:19], 0
    v_cvt_pk_bf16_f32 v66, v84, v85
    v_cvt_pk_bf16_f32 v67, v86, v87
    v_mfma_f32_16x16x32_bf16 v[88:91], a[100:103], a[20:23], v[88:91]
    ds_read_b128 a[8:11], v3 offset:1024
    ds_read_b128 a[12:15], v3 offset:1536
    v_mfma_f32_16x16x32_bf16 v[88:91], a[104:107], a[24:27], v[88:91]
    v_mfma_f32_16x16x32_bf16 v[88:91], a[108:111], a[28:31], v[88:91]
    ds_read_b128 a[144:147], v2 offset:61440
    ds_read_b128 a[148:151], v2 offset:62464
    v_mfma_f32_16x16x32_bf16 v[92:95], a[112:115], a[16:19], 0
    v_mfma_f32_16x16x32_bf16 v[92:95], a[116:119], a[20:23], v[92:95]
    ds_read_b128 a[152:155], v2 offset:63488
    ds_read_b128 a[156:159], v2 offset:64512
    v_mfma_f32_16x16x32_bf16 v[92:95], a[120:123], a[24:27], v[92:95]
    v_mfma_f32_16x16x32_bf16 v[92:95], a[124:127], a[28:31], v[92:95]
    v_exp_f32 v88, v88
    v_mfma_f32_16x16x32_bf16 v[160:163], v[68:71], a[160:163], v[160:163]
    v_exp_f32 v89, v89
    v_mfma_f32_16x16x32_bf16 v[164:167], v[68:71], a[164:167], v[164:167]
    v_exp_f32 v90, v90
    v_mfma_f32_16x16x32_bf16 v[168:171], v[68:71], a[168:171], v[168:171]
    v_exp_f32 v91, v91
    v_mfma_f32_16x16x32_bf16 v[172:175], v[68:71], a[172:175], v[172:175]
    v_exp_f32 v92, v92
    v_mfma_f32_16x16x32_bf16 v[176:179], v[68:71], a[176:179], v[176:179]
    v_exp_f32 v93, v93
    v_mfma_f32_16x16x32_bf16 v[180:183], v[68:71], a[180:183], v[180:183]
    v_exp_f32 v94, v94
    v_mfma_f32_16x16x32_bf16 v[184:187], v[68:71], a[184:187], v[184:187]
    v_exp_f32 v95, v95
    v_mfma_f32_16x16x32_bf16 v[188:191], v[68:71], a[188:191], v[188:191]
    v_mfma_f32_16x16x32_bf16 v[116:119], v[68:71], a[192:195], v[116:119]
    v_cvt_pk_bf16_f32 v68, v88, v89
    v_cvt_pk_bf16_f32 v69, v90, v91
    v_mfma_f32_16x16x32_bf16 v[96:99], a[96:99], a[32:35], 0
    v_cvt_pk_bf16_f32 v70, v92, v93
    v_cvt_pk_bf16_f32 v71, v94, v95
    v_mfma_f32_16x16x32_bf16 v[96:99], a[100:103], a[36:39], v[96:99]
    v_mfma_f32_16x16x32_bf16 v[96:99], a[104:107], a[40:43], v[96:99]
    v_mfma_f32_16x16x32_bf16 v[96:99], a[108:111], a[44:47], v[96:99]
    v_mfma_f32_16x16x32_bf16 v[100:103], a[112:115], a[32:35], 0
    v_mfma_f32_16x16x32_bf16 v[100:103], a[116:119], a[36:39], v[100:103]
    v_mfma_f32_16x16x32_bf16 v[100:103], a[120:123], a[40:43], v[100:103]
    v_mfma_f32_16x16x32_bf16 v[100:103], a[124:127], a[44:47], v[100:103]
    s_nop 3
    v_exp_f32 v96, v96
    v_mfma_f32_16x16x32_bf16 v[192:195], v[72:75], a[160:163], v[192:195]
    v_exp_f32 v97, v97
    v_mfma_f32_16x16x32_bf16 v[196:199], v[72:75], a[164:167], v[196:199]
    v_exp_f32 v98, v98
    v_mfma_f32_16x16x32_bf16 v[200:203], v[72:75], a[168:171], v[200:203]
    v_exp_f32 v99, v99
    v_mfma_f32_16x16x32_bf16 v[204:207], v[72:75], a[172:175], v[204:207]
    v_exp_f32 v100, v100
    v_mfma_f32_16x16x32_bf16 v[208:211], v[72:75], a[176:179], v[208:211]
    v_exp_f32 v101, v101
    v_mfma_f32_16x16x32_bf16 v[212:215], v[72:75], a[180:183], v[212:215]
    v_exp_f32 v102, v102
    v_mfma_f32_16x16x32_bf16 v[216:219], v[72:75], a[184:187], v[216:219]
    v_exp_f32 v103, v103
    v_mfma_f32_16x16x32_bf16 v[220:223], v[72:75], a[188:191], v[220:223]
    v_mfma_f32_16x16x32_bf16 v[120:123], v[72:75], a[192:195], v[120:123]
L_loop:
    s_waitcnt lgkmcnt(4)
    v_mfma_f32_16x16x32_bf16 v[80:83], a[64:67], a[0:3], 0
    v_cvt_pk_bf16_f32 v72, v96, v97
    v_cvt_pk_bf16_f32 v73, v98, v99
    v_mfma_f32_16x16x32_bf16 v[80:83], a[68:71], a[4:7], v[80:83]
    s_add_u32 m0, s31, 0
    v_cvt_pk_bf16_f32 v74, v100, v101
    v_cvt_pk_bf16_f32 v75, v102, v103
    v_mfma_f32_16x16x32_bf16 v[80:83], a[72:75], a[8:11], v[80:83]
    ds_read_b128 a[96:99], v1 offset:8192
    ds_read_b128 a[100:103], v1 offset:8704
    v_mfma_f32_16x16x32_bf16 v[80:83], a[76:79], a[12:15], v[80:83]
    buffer_load_dwordx4 v4, s[12:15], s28 offen offset:0 nt lds
    v_mfma_f32_16x16x32_bf16 v[84:87], a[80:83], a[0:3], 0
    ds_read_b128 a[104:107], v1 offset:9216
    ds_read_b128 a[108:111], v1 offset:9728
    v_mfma_f32_16x16x32_bf16 v[84:87], a[84:87], a[4:7], v[84:87]
    buffer_load_dwordx4 v4, s[12:15], s28 offen offset:2048 nt lds
    v_mfma_f32_16x16x32_bf16 v[84:87], a[88:91], a[8:11], v[84:87]
    s_add_u32 m0, s31, 1024
    ds_read_b128 a[112:115], v1 offset:12288
    ds_read_b128 a[116:119], v1 offset:12800
    v_mfma_f32_16x16x32_bf16 v[84:87], a[92:95], a[12:15], v[84:87]
    s_waitcnt lgkmcnt(6)
    v_exp_f32 v80, v80
    v_mfma_f32_16x16x32_bf16 v[128:131], v[64:67], a[128:131], v[128:131]
    v_exp_f32 v81, v81
    v_mfma_f32_16x16x32_bf16 v[132:135], v[64:67], a[132:135], v[132:135]
    v_exp_f32 v82, v82
    v_mfma_f32_16x16x32_bf16 v[136:139], v[64:67], a[136:139], v[136:139]
    v_exp_f32 v83, v83
    v_mfma_f32_16x16x32_bf16 v[140:143], v[64:67], a[140:143], v[140:143]
    v_exp_f32 v84, v84
    v_mfma_f32_16x16x32_bf16 v[144:147], v[64:67], a[144:147], v[144:147]
    v_exp_f32 v85, v85
    v_mfma_f32_16x16x32_bf16 v[148:151], v[64:67], a[148:151], v[148:151]
    v_exp_f32 v86, v86
    v_mfma_f32_16x16x32_bf16 v[152:155], v[64:67], a[152:155], v[152:155]
    v_exp_f32 v87, v87
    v_mfma_f32_16x16x32_bf16 v[156:159], v[64:67], a[156:159], v[156:159]
    ds_read_b128 a[120:123], v1 offset:13312
    ds_read_b128 a[124:127], v1 offset:13824
    v_mfma_f32_16x16x32_bf16 v[112:115], v[64:67], a[192:195], v[112:115]
    v_cvt_pk_bf16_f32 v64, v80, v81
    v_cvt_pk_bf16_f32 v65, v82, v83
    v_mfma_f32_16x16x32_bf16 v[88:91], a[64:67], a[16:19], 0
    v_cvt_pk_bf16_f32 v66, v84, v85
    v_cvt_pk_bf16_f32 v67, v86, v87
    v_mfma_f32_16x16x32_bf16 v[88:91], a[68:71], a[20:23], v[88:91]
    ds_read_b128 a[160:163], v2 offset:0
    ds_read_b128 a[164:167], v2 offset:1024
    v_mfma_f32_16x16x32_bf16 v[88:91], a[72:75], a[24:27], v[88:91]
    buffer_load_dwordx4 v4, s[12:15], s29 offen offset:0 nt lds
    v_mfma_f32_16x16x32_bf16 v[88:91], a[76:79], a[28:31], v[88:91]
    ds_read_b128 a[168:171], v2 offset:2048
    ds_read_b128 a[172:175], v2 offset:3072
    v_mfma_f32_16x16x32_bf16 v[92:95], a[80:83], a[16:19], 0
    v_rcp_f32 v24, v112
    v_mfma_f32_16x16x32_bf16 v[92:95], a[84:87], a[20:23], v[92:95]
    ds_read_b128 a[176:179], v2 offset:4096
    ds_read_b128 a[180:183], v2 offset:5120
    v_mfma_f32_16x16x32_bf16 v[92:95], a[88:91], a[24:27], v[92:95]
    v_rcp_f32 v25, v113
    v_mfma_f32_16x16x32_bf16 v[92:95], a[92:95], a[28:31], v[92:95]
    v_exp_f32 v88, v88
    v_mfma_f32_16x16x32_bf16 v[160:163], v[68:71], a[128:131], v[160:163]
    v_exp_f32 v89, v89
    v_mfma_f32_16x16x32_bf16 v[164:167], v[68:71], a[132:135], v[164:167]
    v_exp_f32 v90, v90
    v_mfma_f32_16x16x32_bf16 v[168:171], v[68:71], a[136:139], v[168:171]
    v_exp_f32 v91, v91
    v_mfma_f32_16x16x32_bf16 v[172:175], v[68:71], a[140:143], v[172:175]
    v_exp_f32 v92, v92
    v_mfma_f32_16x16x32_bf16 v[176:179], v[68:71], a[144:147], v[176:179]
    v_exp_f32 v93, v93
    v_mfma_f32_16x16x32_bf16 v[180:183], v[68:71], a[148:151], v[180:183]
    v_exp_f32 v94, v94
    v_mfma_f32_16x16x32_bf16 v[184:187], v[68:71], a[152:155], v[184:187]
    v_exp_f32 v95, v95
    v_mfma_f32_16x16x32_bf16 v[188:191], v[68:71], a[156:159], v[188:191]
    ds_read_b128 a[184:187], v2 offset:6144
    ds_read_b128 a[188:191], v2 offset:7168
    v_mfma_f32_16x16x32_bf16 v[116:119], v[68:71], a[192:195], v[116:119]
    v_cvt_pk_bf16_f32 v68, v88, v89
    v_cvt_pk_bf16_f32 v69, v90, v91
    v_mfma_f32_16x16x32_bf16 v[96:99], a[64:67], a[32:35], 0
    v_cvt_pk_bf16_f32 v70, v92, v93
    v_cvt_pk_bf16_f32 v71, v94, v95
    v_mfma_f32_16x16x32_bf16 v[96:99], a[68:71], a[36:39], v[96:99]
    v_rcp_f32 v26, v114
    v_mfma_f32_16x16x32_bf16 v[96:99], a[72:75], a[40:43], v[96:99]
    v_rcp_f32 v27, v115
    v_mfma_f32_16x16x32_bf16 v[96:99], a[76:79], a[44:47], v[96:99]
    v_mul_f32 v32, v128, v24
    v_mul_f32 v33, v132, v24
    v_mfma_f32_16x16x32_bf16 v[100:103], a[80:83], a[32:35], 0
    v_mul_f32 v34, v136, v24
    v_mul_f32 v35, v140, v24
    v_mfma_f32_16x16x32_bf16 v[100:103], a[84:87], a[36:39], v[100:103]
    v_mul_f32 v36, v144, v24
    v_mul_f32 v37, v148, v24
    v_mfma_f32_16x16x32_bf16 v[100:103], a[88:91], a[40:43], v[100:103]
    v_mul_f32 v38, v152, v24
    v_mul_f32 v39, v156, v24
    v_mfma_f32_16x16x32_bf16 v[100:103], a[92:95], a[44:47], v[100:103]
    v_exp_f32 v96, v96
    v_mfma_f32_16x16x32_bf16 v[192:195], v[72:75], a[128:131], v[192:195]
    v_exp_f32 v97, v97
    v_mfma_f32_16x16x32_bf16 v[196:199], v[72:75], a[132:135], v[196:199]
    v_exp_f32 v98, v98
    v_mfma_f32_16x16x32_bf16 v[200:203], v[72:75], a[136:139], v[200:203]
    v_exp_f32 v99, v99
    v_mfma_f32_16x16x32_bf16 v[204:207], v[72:75], a[140:143], v[204:207]
    v_exp_f32 v100, v100
    v_mfma_f32_16x16x32_bf16 v[208:211], v[72:75], a[144:147], v[208:211]
    v_exp_f32 v101, v101
    v_mfma_f32_16x16x32_bf16 v[212:215], v[72:75], a[148:151], v[212:215]
    v_exp_f32 v102, v102
    v_mfma_f32_16x16x32_bf16 v[216:219], v[72:75], a[152:155], v[216:219]
    v_exp_f32 v103, v103
    v_mfma_f32_16x16x32_bf16 v[220:223], v[72:75], a[156:159], v[220:223]
    v_mul_f32 v40, v129, v25
    v_mul_f32 v41, v133, v25
    v_mfma_f32_16x16x32_bf16 v[120:123], v[72:75], a[192:195], v[120:123]
    v_cvt_pk_bf16_f32 v72, v96, v97
    v_cvt_pk_bf16_f32 v73, v98, v99
    v_mfma_f32_16x16x32_bf16 v[104:107], a[64:67], a[48:51], 0
    v_cvt_pk_bf16_f32 v74, v100, v101
    v_cvt_pk_bf16_f32 v75, v102, v103
    v_mfma_f32_16x16x32_bf16 v[104:107], a[68:71], a[52:55], v[104:107]
    v_mul_f32 v42, v137, v25
    v_mul_f32 v43, v141, v25
    v_mfma_f32_16x16x32_bf16 v[104:107], a[72:75], a[56:59], v[104:107]
    v_mul_f32 v44, v145, v25
    v_mul_f32 v45, v149, v25
    v_mfma_f32_16x16x32_bf16 v[104:107], a[76:79], a[60:63], v[104:107]
    v_mul_f32 v46, v153, v25
    v_mul_f32 v47, v157, v25
    v_mfma_f32_16x16x32_bf16 v[108:111], a[80:83], a[48:51], 0
    v_mul_f32 v48, v130, v26
    v_mul_f32 v49, v134, v26
    v_mfma_f32_16x16x32_bf16 v[108:111], a[84:87], a[52:55], v[108:111]
    v_mul_f32 v50, v138, v26
    v_mul_f32 v51, v142, v26
    v_mfma_f32_16x16x32_bf16 v[108:111], a[88:91], a[56:59], v[108:111]
    v_mul_f32 v52, v146, v26
    v_mul_f32 v53, v150, v26
    v_mfma_f32_16x16x32_bf16 v[108:111], a[92:95], a[60:63], v[108:111]
    v_exp_f32 v104, v104
    v_mfma_f32_16x16x32_bf16 v[224:227], v[76:79], a[128:131], v[224:227]
    v_exp_f32 v105, v105
    v_mfma_f32_16x16x32_bf16 v[228:231], v[76:79], a[132:135], v[228:231]
    v_exp_f32 v106, v106
    v_mfma_f32_16x16x32_bf16 v[232:235], v[76:79], a[136:139], v[232:235]
    v_exp_f32 v107, v107
    v_mfma_f32_16x16x32_bf16 v[236:239], v[76:79], a[140:143], v[236:239]
    v_exp_f32 v108, v108
    v_mfma_f32_16x16x32_bf16 v[240:243], v[76:79], a[144:147], v[240:243]
    v_exp_f32 v109, v109
    v_mfma_f32_16x16x32_bf16 v[244:247], v[76:79], a[148:151], v[244:247]
    v_exp_f32 v110, v110
    v_mfma_f32_16x16x32_bf16 v[248:251], v[76:79], a[152:155], v[248:251]
    v_exp_f32 v111, v111
    v_mfma_f32_16x16x32_bf16 v[252:255], v[76:79], a[156:159], v[252:255]
    v_mul_f32 v54, v154, v26
    v_mul_f32 v55, v158, v26
    v_mfma_f32_16x16x32_bf16 v[124:127], v[76:79], a[192:195], v[124:127]
    s_waitcnt lgkmcnt(8)
    v_mul_f32 v56, v131, v27
    v_mul_f32 v57, v135, v27
    v_mfma_f32_16x16x32_bf16 v[80:83], a[96:99], a[0:3], 0
    v_mul_f32 v58, v139, v27
    v_mul_f32 v59, v143, v27
    v_mfma_f32_16x16x32_bf16 v[80:83], a[100:103], a[4:7], v[80:83]
    v_mul_f32 v60, v147, v27
    v_mul_f32 v61, v151, v27
    v_mfma_f32_16x16x32_bf16 v[80:83], a[104:107], a[8:11], v[80:83]
    v_mul_f32 v62, v155, v27
    v_mul_f32 v63, v159, v27
    v_mfma_f32_16x16x32_bf16 v[80:83], a[108:111], a[12:15], v[80:83]
    v_cvt_pk_bf16_f32 v76, v104, v105
    v_cvt_pk_bf16_f32 v77, v106, v107
    v_mfma_f32_16x16x32_bf16 v[84:87], a[112:115], a[0:3], 0
    v_cvt_pk_bf16_f32 v78, v108, v109
    v_cvt_pk_bf16_f32 v79, v110, v111
    v_mfma_f32_16x16x32_bf16 v[84:87], a[116:119], a[4:7], v[84:87]
    buffer_load_dwordx4 v4, s[12:15], s29 offen offset:2048 nt lds
    v_mfma_f32_16x16x32_bf16 v[84:87], a[120:123], a[8:11], v[84:87]
    s_add_u32 s28, s28, 0x4000
    s_add_u32 s29, s29, 0x4000
    ds_read_b128 a[64:67], v1 offset:16384
    v_mfma_f32_16x16x32_bf16 v[84:87], a[124:127], a[12:15], v[84:87]
    s_waitcnt lgkmcnt(1)
    v_exp_f32 v80, v80
    v_mfma_f32_16x16x32_bf16 v[128:131], v[64:67], a[160:163], 0
    v_exp_f32 v81, v81
    v_mfma_f32_16x16x32_bf16 v[132:135], v[64:67], a[164:167], 0
    v_exp_f32 v82, v82
    v_mfma_f32_16x16x32_bf16 v[136:139], v[64:67], a[168:171], 0
    v_exp_f32 v83, v83
    v_mfma_f32_16x16x32_bf16 v[140:143], v[64:67], a[172:175], 0
    v_exp_f32 v84, v84
    v_mfma_f32_16x16x32_bf16 v[144:147], v[64:67], a[176:179], 0
    v_exp_f32 v85, v85
    v_mfma_f32_16x16x32_bf16 v[148:151], v[64:67], a[180:183], 0
    v_exp_f32 v86, v86
    v_mfma_f32_16x16x32_bf16 v[152:155], v[64:67], a[184:187], 0
    v_exp_f32 v87, v87
    v_mfma_f32_16x16x32_bf16 v[156:159], v[64:67], a[188:191], 0
    ds_read_b128 a[68:71], v1 offset:16896
    ds_read_b128 a[72:75], v1 offset:17408
    v_mfma_f32_16x16x32_bf16 v[112:115], v[64:67], a[192:195], 0
    v_cvt_pk_bf16_f32 v64, v80, v81
    v_cvt_pk_bf16_f32 v65, v82, v83
    v_mfma_f32_16x16x32_bf16 v[88:91], a[96:99], a[16:19], 0
    v_cvt_pk_bf16_f32 v66, v84, v85
    v_cvt_pk_bf16_f32 v67, v86, v87
    v_mfma_f32_16x16x32_bf16 v[88:91], a[100:103], a[20:23], v[88:91]
    ds_read_b128 a[76:79], v1 offset:17920
    ds_read_b128 a[80:83], v1 offset:20480
    v_mfma_f32_16x16x32_bf16 v[88:91], a[104:107], a[24:27], v[88:91]
    v_cvt_pk_bf16_f32 v32, v32, v33
    v_cvt_pk_bf16_f32 v33, v34, v35
    v_mfma_f32_16x16x32_bf16 v[88:91], a[108:111], a[28:31], v[88:91]
    ds_read_b128 a[84:87], v1 offset:20992
    ds_read_b128 a[88:91], v1 offset:21504
    v_mfma_f32_16x16x32_bf16 v[92:95], a[112:115], a[16:19], 0
    v_cvt_pk_bf16_f32 v34, v36, v37
    v_cvt_pk_bf16_f32 v35, v38, v39
    v_mfma_f32_16x16x32_bf16 v[92:95], a[116:119], a[20:23], v[92:95]
    ds_read_b128 a[92:95], v1 offset:22016
    ds_read_b128 a[128:131], v2 offset:8192
    v_mfma_f32_16x16x32_bf16 v[92:95], a[120:123], a[24:27], v[92:95]
    v_cvt_pk_bf16_f32 v40, v40, v41
    v_cvt_pk_bf16_f32 v41, v42, v43
    v_mfma_f32_16x16x32_bf16 v[92:95], a[124:127], a[28:31], v[92:95]
    v_exp_f32 v88, v88
    v_mfma_f32_16x16x32_bf16 v[160:163], v[68:71], a[160:163], v[160:163]
    v_exp_f32 v89, v89
    v_mfma_f32_16x16x32_bf16 v[164:167], v[68:71], a[164:167], v[164:167]
    v_exp_f32 v90, v90
    v_mfma_f32_16x16x32_bf16 v[168:171], v[68:71], a[168:171], v[168:171]
    v_exp_f32 v91, v91
    v_mfma_f32_16x16x32_bf16 v[172:175], v[68:71], a[172:175], v[172:175]
    v_exp_f32 v92, v92
    v_mfma_f32_16x16x32_bf16 v[176:179], v[68:71], a[176:179], v[176:179]
    v_exp_f32 v93, v93
    v_mfma_f32_16x16x32_bf16 v[180:183], v[68:71], a[180:183], v[180:183]
    v_exp_f32 v94, v94
    v_mfma_f32_16x16x32_bf16 v[184:187], v[68:71], a[184:187], v[184:187]
    v_exp_f32 v95, v95
    v_mfma_f32_16x16x32_bf16 v[188:191], v[68:71], a[188:191], v[188:191]
    s_waitcnt vmcnt(4)
    ds_read_b128 a[16:19], v3 offset:4096
    ds_read_b128 a[20:23], v3 offset:4608
    v_mfma_f32_16x16x32_bf16 v[116:119], v[68:71], a[192:195], v[116:119]
    v_cvt_pk_bf16_f32 v68, v88, v89
    v_cvt_pk_bf16_f32 v69, v90, v91
    v_mfma_f32_16x16x32_bf16 v[96:99], a[96:99], a[32:35], 0
    v_cvt_pk_bf16_f32 v70, v92, v93
    v_cvt_pk_bf16_f32 v71, v94, v95
    v_mfma_f32_16x16x32_bf16 v[96:99], a[100:103], a[36:39], v[96:99]
    ds_read_b128 a[24:27], v3 offset:5120
    ds_read_b128 a[28:31], v3 offset:5632
    v_mfma_f32_16x16x32_bf16 v[96:99], a[104:107], a[40:43], v[96:99]
    v_cvt_pk_bf16_f32 v42, v44, v45
    v_cvt_pk_bf16_f32 v43, v46, v47
    v_mfma_f32_16x16x32_bf16 v[96:99], a[108:111], a[44:47], v[96:99]
    ds_read_b128 a[132:135], v2 offset:9216
    ds_read_b128 a[136:139], v2 offset:10240
    v_mfma_f32_16x16x32_bf16 v[100:103], a[112:115], a[32:35], 0
    buffer_store_dwordx4 v[32:35], v5, s[24:27], s30 offen offset:0 sc1
    v_mfma_f32_16x16x32_bf16 v[100:103], a[116:119], a[36:39], v[100:103]
    ds_read_b128 a[140:143], v2 offset:11264
    ds_read_b128 a[144:147], v2 offset:12288
    v_mfma_f32_16x16x32_bf16 v[100:103], a[120:123], a[40:43], v[100:103]
    v_cvt_pk_bf16_f32 v48, v48, v49
    v_cvt_pk_bf16_f32 v49, v50, v51
    v_mfma_f32_16x16x32_bf16 v[100:103], a[124:127], a[44:47], v[100:103]
    v_exp_f32 v96, v96
    v_mfma_f32_16x16x32_bf16 v[192:195], v[72:75], a[160:163], v[192:195]
    v_exp_f32 v97, v97
    v_mfma_f32_16x16x32_bf16 v[196:199], v[72:75], a[164:167], v[196:199]
    v_exp_f32 v98, v98
    v_mfma_f32_16x16x32_bf16 v[200:203], v[72:75], a[168:171], v[200:203]
    v_exp_f32 v99, v99
    v_mfma_f32_16x16x32_bf16 v[204:207], v[72:75], a[172:175], v[204:207]
    v_exp_f32 v100, v100
    v_mfma_f32_16x16x32_bf16 v[208:211], v[72:75], a[176:179], v[208:211]
    v_exp_f32 v101, v101
    v_mfma_f32_16x16x32_bf16 v[212:215], v[72:75], a[180:183], v[212:215]
    v_exp_f32 v102, v102
    v_mfma_f32_16x16x32_bf16 v[216:219], v[72:75], a[184:187], v[216:219]
    v_exp_f32 v103, v103
    v_mfma_f32_16x16x32_bf16 v[220:223], v[72:75], a[188:191], v[220:223]
    ds_read_b128 a[148:151], v2 offset:13312
    ds_read_b128 a[152:155], v2 offset:14336
    v_mfma_f32_16x16x32_bf16 v[120:123], v[72:75], a[192:195], v[120:123]
    v_cvt_pk_bf16_f32 v72, v96, v97
    v_cvt_pk_bf16_f32 v73, v98, v99
    v_mfma_f32_16x16x32_bf16 v[104:107], a[96:99], a[48:51], 0
    ds_read_b128 a[156:159], v2 offset:15360
    v_cvt_pk_bf16_f32 v74, v100, v101
    v_mfma_f32_16x16x32_bf16 v[104:107], a[100:103], a[52:55], v[104:107]
    v_cvt_pk_bf16_f32 v75, v102, v103
    v_cvt_pk_bf16_f32 v50, v52, v53
    v_mfma_f32_16x16x32_bf16 v[104:107], a[104:107], a[56:59], v[104:107]
    v_cvt_pk_bf16_f32 v51, v54, v55
    v_mfma_f32_16x16x32_bf16 v[104:107], a[108:111], a[60:63], v[104:107]
    buffer_store_dwordx4 v[40:43], v5, s[24:27], s30 offen offset:256 sc1
    v_mfma_f32_16x16x32_bf16 v[108:111], a[112:115], a[48:51], 0
    v_cvt_pk_bf16_f32 v56, v56, v57
    v_cvt_pk_bf16_f32 v57, v58, v59
    v_mfma_f32_16x16x32_bf16 v[108:111], a[116:119], a[52:55], v[108:111]
    v_cvt_pk_bf16_f32 v58, v60, v61
    v_cvt_pk_bf16_f32 v59, v62, v63
    v_mfma_f32_16x16x32_bf16 v[108:111], a[120:123], a[56:59], v[108:111]
    buffer_store_dwordx4 v[48:51], v5, s[24:27], s30 offen offset:512 sc1
    v_mfma_f32_16x16x32_bf16 v[108:111], a[124:127], a[60:63], v[108:111]
    v_exp_f32 v104, v104
    v_mfma_f32_16x16x32_bf16 v[224:227], v[76:79], a[160:163], v[224:227]
    v_exp_f32 v105, v105
    v_mfma_f32_16x16x32_bf16 v[228:231], v[76:79], a[164:167], v[228:231]
    v_exp_f32 v106, v106
    v_mfma_f32_16x16x32_bf16 v[232:235], v[76:79], a[168:171], v[232:235]
    v_exp_f32 v107, v107
    v_mfma_f32_16x16x32_bf16 v[236:239], v[76:79], a[172:175], v[236:239]
    v_exp_f32 v108, v108
    v_mfma_f32_16x16x32_bf16 v[240:243], v[76:79], a[176:179], v[240:243]
    v_exp_f32 v109, v109
    v_mfma_f32_16x16x32_bf16 v[244:247], v[76:79], a[180:183], v[244:247]
    v_exp_f32 v110, v110
    v_mfma_f32_16x16x32_bf16 v[248:251], v[76:79], a[184:187], v[248:251]
    v_exp_f32 v111, v111
    v_mfma_f32_16x16x32_bf16 v[252:255], v[76:79], a[188:191], v[252:255]
    v_max3_f32 v28, v28, v24, v25
    v_min3_f32 v29, v29, v24, v25
    v_mfma_f32_16x16x32_bf16 v[124:127], v[76:79], a[192:195], v[124:127]
    s_waitcnt lgkmcnt(7)
    v_cvt_pk_bf16_f32 v76, v104, v105
    v_cvt_pk_bf16_f32 v77, v106, v107
    v_mfma_f32_16x16x32_bf16 v[88:91], a[64:67], a[16:19], 0
    v_cvt_pk_bf16_f32 v78, v108, v109
    v_cvt_pk_bf16_f32 v79, v110, v111
    v_mfma_f32_16x16x32_bf16 v[88:91], a[68:71], a[20:23], v[88:91]
    s_add_u32 m0, s31, 4096
    v_max3_f32 v28, v28, v26, v27
    v_min3_f32 v29, v29, v26, v27
    v_mfma_f32_16x16x32_bf16 v[88:91], a[72:75], a[24:27], v[88:91]
    buffer_store_dwordx4 v[56:59], v5, s[24:27], s30 offen offset:768 sc1
    v_mfma_f32_16x16x32_bf16 v[88:91], a[76:79], a[28:31], v[88:91]
    s_add_u32 s30, s30, 0x4000
    ds_read_b128 a[96:99], v1 offset:24576
    ds_read_b128 a[100:103], v1 offset:25088
    v_mfma_f32_16x16x32_bf16 v[92:95], a[80:83], a[16:19], 0
    buffer_load_dwordx4 v4, s[12:15], s28 offen offset:0 nt lds
    v_mfma_f32_16x16x32_bf16 v[92:95], a[84:87], a[20:23], v[92:95]
    ds_read_b128 a[104:107], v1 offset:25600
    ds_read_b128 a[108:111], v1 offset:26112
    v_mfma_f32_16x16x32_bf16 v[92:95], a[88:91], a[24:27], v[92:95]
    buffer_load_dwordx4 v4, s[12:15], s28 offen offset:2048 nt lds
    v_mfma_f32_16x16x32_bf16 v[92:95], a[92:95], a[28:31], v[92:95]
    s_waitcnt lgkmcnt(4)
    v_exp_f32 v88, v88
    v_mfma_f32_16x16x32_bf16 v[160:163], v[68:71], a[128:131], v[160:163]
    s_add_u32 m0, s31, 5120
    v_exp_f32 v89, v89
    v_mfma_f32_16x16x32_bf16 v[164:167], v[68:71], a[132:135], v[164:167]
    v_exp_f32 v90, v90
    v_mfma_f32_16x16x32_bf16 v[168:171], v[68:71], a[136:139], v[168:171]
    v_exp_f32 v91, v91
    v_mfma_f32_16x16x32_bf16 v[172:175], v[68:71], a[140:143], v[172:175]
    v_exp_f32 v92, v92
    v_mfma_f32_16x16x32_bf16 v[176:179], v[68:71], a[144:147], v[176:179]
    v_exp_f32 v93, v93
    v_mfma_f32_16x16x32_bf16 v[180:183], v[68:71], a[148:151], v[180:183]
    v_exp_f32 v94, v94
    v_mfma_f32_16x16x32_bf16 v[184:187], v[68:71], a[152:155], v[184:187]
    v_exp_f32 v95, v95
    v_mfma_f32_16x16x32_bf16 v[188:191], v[68:71], a[156:159], v[188:191]
    ds_read_b128 a[112:115], v1 offset:28672
    ds_read_b128 a[116:119], v1 offset:29184
    v_mfma_f32_16x16x32_bf16 v[116:119], v[68:71], a[192:195], v[116:119]
    v_cvt_pk_bf16_f32 v68, v88, v89
    v_cvt_pk_bf16_f32 v69, v90, v91
    v_mfma_f32_16x16x32_bf16 v[96:99], a[64:67], a[32:35], 0
    v_cvt_pk_bf16_f32 v70, v92, v93
    v_cvt_pk_bf16_f32 v71, v94, v95
    v_mfma_f32_16x16x32_bf16 v[96:99], a[68:71], a[36:39], v[96:99]
    ds_read_b128 a[120:123], v1 offset:29696
    ds_read_b128 a[124:127], v1 offset:30208
    v_mfma_f32_16x16x32_bf16 v[96:99], a[72:75], a[40:43], v[96:99]
    buffer_load_dwordx4 v4, s[12:15], s29 offen offset:0 nt lds
    v_mfma_f32_16x16x32_bf16 v[96:99], a[76:79], a[44:47], v[96:99]
    ds_read_b128 a[160:163], v2 offset:16384
    ds_read_b128 a[164:167], v2 offset:17408
    v_mfma_f32_16x16x32_bf16 v[100:103], a[80:83], a[32:35], 0
    v_rcp_f32 v24, v116
    v_mfma_f32_16x16x32_bf16 v[100:103], a[84:87], a[36:39], v[100:103]
    ds_read_b128 a[168:171], v2 offset:18432
    ds_read_b128 a[172:175], v2 offset:19456
    v_mfma_f32_16x16x32_bf16 v[100:103], a[88:91], a[40:43], v[100:103]
    v_rcp_f32 v25, v117
    v_mfma_f32_16x16x32_bf16 v[100:103], a[92:95], a[44:47], v[100:103]
    v_exp_f32 v96, v96
    v_mfma_f32_16x16x32_bf16 v[192:195], v[72:75], a[128:131], v[192:195]
    v_exp_f32 v97, v97
    v_mfma_f32_16x16x32_bf16 v[196:199], v[72:75], a[132:135], v[196:199]
    v_exp_f32 v98, v98
    v_mfma_f32_16x16x32_bf16 v[200:203], v[72:75], a[136:139], v[200:203]
    v_exp_f32 v99, v99
    v_mfma_f32_16x16x32_bf16 v[204:207], v[72:75], a[140:143], v[204:207]
    v_exp_f32 v100, v100
    v_mfma_f32_16x16x32_bf16 v[208:211], v[72:75], a[144:147], v[208:211]
    v_exp_f32 v101, v101
    v_mfma_f32_16x16x32_bf16 v[212:215], v[72:75], a[148:151], v[212:215]
    v_exp_f32 v102, v102
    v_mfma_f32_16x16x32_bf16 v[216:219], v[72:75], a[152:155], v[216:219]
    v_exp_f32 v103, v103
    v_mfma_f32_16x16x32_bf16 v[220:223], v[72:75], a[156:159], v[220:223]
    ds_read_b128 a[176:179], v2 offset:20480
    ds_read_b128 a[180:183], v2 offset:21504
    v_mfma_f32_16x16x32_bf16 v[120:123], v[72:75], a[192:195], v[120:123]
    v_cvt_pk_bf16_f32 v72, v96, v97
    v_cvt_pk_bf16_f32 v73, v98, v99
    v_mfma_f32_16x16x32_bf16 v[104:107], a[64:67], a[48:51], 0
    v_cvt_pk_bf16_f32 v74, v100, v101
    v_cvt_pk_bf16_f32 v75, v102, v103
    v_mfma_f32_16x16x32_bf16 v[104:107], a[68:71], a[52:55], v[104:107]
    ds_read_b128 a[184:187], v2 offset:22528
    ds_read_b128 a[188:191], v2 offset:23552
    v_mfma_f32_16x16x32_bf16 v[104:107], a[72:75], a[56:59], v[104:107]
    v_rcp_f32 v26, v118
    v_mfma_f32_16x16x32_bf16 v[104:107], a[76:79], a[60:63], v[104:107]
    v_rcp_f32 v27, v119
    v_mfma_f32_16x16x32_bf16 v[108:111], a[80:83], a[48:51], 0
    v_mul_f32 v32, v160, v24
    v_mul_f32 v33, v164, v24
    v_mfma_f32_16x16x32_bf16 v[108:111], a[84:87], a[52:55], v[108:111]
    v_mul_f32 v34, v168, v24
    v_mul_f32 v35, v172, v24
    v_mfma_f32_16x16x32_bf16 v[108:111], a[88:91], a[56:59], v[108:111]
    v_mul_f32 v36, v176, v24
    v_mul_f32 v37, v180, v24
    v_mfma_f32_16x16x32_bf16 v[108:111], a[92:95], a[60:63], v[108:111]
    v_exp_f32 v104, v104
    v_mfma_f32_16x16x32_bf16 v[224:227], v[76:79], a[128:131], v[224:227]
    v_exp_f32 v105, v105
    v_mfma_f32_16x16x32_bf16 v[228:231], v[76:79], a[132:135], v[228:231]
    v_exp_f32 v106, v106
    v_mfma_f32_16x16x32_bf16 v[232:235], v[76:79], a[136:139], v[232:235]
    v_exp_f32 v107, v107
    v_mfma_f32_16x16x32_bf16 v[236:239], v[76:79], a[140:143], v[236:239]
    v_exp_f32 v108, v108
    v_mfma_f32_16x16x32_bf16 v[240:243], v[76:79], a[144:147], v[240:243]
    v_exp_f32 v109, v109
    v_mfma_f32_16x16x32_bf16 v[244:247], v[76:79], a[148:151], v[244:247]
    v_exp_f32 v110, v110
    v_mfma_f32_16x16x32_bf16 v[248:251], v[76:79], a[152:155], v[248:251]
    v_exp_f32 v111, v111
    v_mfma_f32_16x16x32_bf16 v[252:255], v[76:79], a[156:159], v[252:255]
    v_mul_f32 v38, v184, v24
    v_mul_f32 v39, v188, v24
    v_mfma_f32_16x16x32_bf16 v[124:127], v[76:79], a[192:195], v[124:127]
    v_cvt_pk_bf16_f32 v76, v104, v105
    v_cvt_pk_bf16_f32 v77, v106, v107
    v_mfma_f32_16x16x32_bf16 v[80:83], a[64:67], a[0:3], 0
    v_cvt_pk_bf16_f32 v78, v108, v109
    v_cvt_pk_bf16_f32 v79, v110, v111
    v_mfma_f32_16x16x32_bf16 v[80:83], a[68:71], a[4:7], v[80:83]
    v_mul_f32 v40, v161, v25
    v_mul_f32 v41, v165, v25
    v_mfma_f32_16x16x32_bf16 v[80:83], a[72:75], a[8:11], v[80:83]
    v_mul_f32 v42, v169, v25
    v_mul_f32 v43, v173, v25
    v_mfma_f32_16x16x32_bf16 v[80:83], a[76:79], a[12:15], v[80:83]
    v_mul_f32 v44, v177, v25
    v_mul_f32 v45, v181, v25
    v_mfma_f32_16x16x32_bf16 v[84:87], a[80:83], a[0:3], 0
    v_mul_f32 v46, v185, v25
    v_mul_f32 v47, v189, v25
    v_mfma_f32_16x16x32_bf16 v[84:87], a[84:87], a[4:7], v[84:87]
    v_mul_f32 v48, v162, v26
    v_mul_f32 v49, v166, v26
    v_mfma_f32_16x16x32_bf16 v[84:87], a[88:91], a[8:11], v[84:87]
    v_mul_f32 v50, v170, v26
    v_mul_f32 v51, v174, v26
    v_mfma_f32_16x16x32_bf16 v[84:87], a[92:95], a[12:15], v[84:87]
    v_exp_f32 v80, v80
    v_mfma_f32_16x16x32_bf16 v[128:131], v[64:67], a[128:131], v[128:131]
    v_exp_f32 v81, v81
    v_mfma_f32_16x16x32_bf16 v[132:135], v[64:67], a[132:135], v[132:135]
    v_exp_f32 v82, v82
    v_mfma_f32_16x16x32_bf16 v[136:139], v[64:67], a[136:139], v[136:139]
    v_exp_f32 v83, v83
    v_mfma_f32_16x16x32_bf16 v[140:143], v[64:67], a[140:143], v[140:143]
    v_exp_f32 v84, v84
    v_mfma_f32_16x16x32_bf16 v[144:147], v[64:67], a[144:147], v[144:147]
    v_exp_f32 v85, v85
    v_mfma_f32_16x16x32_bf16 v[148:151], v[64:67], a[148:151], v[148:151]
    v_exp_f32 v86, v86
    v_mfma_f32_16x16x32_bf16 v[152:155], v[64:67], a[152:155], v[152:155]
    v_exp_f32 v87, v87
    v_mfma_f32_16x16x32_bf16 v[156:159], v[64:67], a[156:159], v[156:159]
    v_mul_f32 v52, v178, v26
    v_mul_f32 v53, v182, v26
    v_mfma_f32_16x16x32_bf16 v[112:115], v[64:67], a[192:195], v[112:115]
    s_waitcnt lgkmcnt(8)
    v_mul_f32 v54, v186, v26
    v_mul_f32 v55, v190, v26
    v_mfma_f32_16x16x32_bf16 v[88:91], a[96:99], a[16:19], 0
    v_mul_f32 v56, v163, v27
    v_mul_f32 v57, v167, v27
    v_mfma_f32_16x16x32_bf16 v[88:91], a[100:103], a[20:23], v[88:91]
    v_mul_f32 v58, v171, v27
    v_mul_f32 v59, v175, v27
    v_mfma_f32_16x16x32_bf16 v[88:91], a[104:107], a[24:27], v[88:91]
    v_mul_f32 v60, v179, v27
    v_mul_f32 v61, v183, v27
    v_mfma_f32_16x16x32_bf16 v[88:91], a[108:111], a[28:31], v[88:91]
    v_mul_f32 v62, v187, v27
    v_mul_f32 v63, v191, v27
    v_mfma_f32_16x16x32_bf16 v[92:95], a[112:115], a[16:19], 0
    v_cvt_pk_bf16_f32 v64, v80, v81
    v_cvt_pk_bf16_f32 v65, v82, v83
    v_mfma_f32_16x16x32_bf16 v[92:95], a[116:119], a[20:23], v[92:95]
    v_cvt_pk_bf16_f32 v66, v84, v85
    v_cvt_pk_bf16_f32 v67, v86, v87
    v_mfma_f32_16x16x32_bf16 v[92:95], a[120:123], a[24:27], v[92:95]
    buffer_load_dwordx4 v4, s[12:15], s29 offen offset:2048 nt lds
    v_mfma_f32_16x16x32_bf16 v[92:95], a[124:127], a[28:31], v[92:95]
    s_waitcnt lgkmcnt(0)
    v_exp_f32 v88, v88
    v_mfma_f32_16x16x32_bf16 v[160:163], v[68:71], a[160:163], 0
    s_add_u32 s28, s28, 0x4000
    v_exp_f32 v89, v89
    v_mfma_f32_16x16x32_bf16 v[164:167], v[68:71], a[164:167], 0
    s_add_u32 s29, s29, 0x4000
    v_exp_f32 v90, v90
    v_mfma_f32_16x16x32_bf16 v[168:171], v[68:71], a[168:171], 0
    v_exp_f32 v91, v91
    v_mfma_f32_16x16x32_bf16 v[172:175], v[68:71], a[172:175], 0
    v_exp_f32 v92, v92
    v_mfma_f32_16x16x32_bf16 v[176:179], v[68:71], a[176:179], 0
    v_exp_f32 v93, v93
    v_mfma_f32_16x16x32_bf16 v[180:183], v[68:71], a[180:183], 0
    v_exp_f32 v94, v94
    v_mfma_f32_16x16x32_bf16 v[184:187], v[68:71], a[184:187], 0
    v_exp_f32 v95, v95
    v_mfma_f32_16x16x32_bf16 v[188:191], v[68:71], a[188:191], 0
    ds_read_b128 a[64:67], v1 offset:32768
    ds_read_b128 a[68:71], v1 offset:33280
    v_mfma_f32_16x16x32_bf16 v[116:119], v[68:71], a[192:195], 0
    v_cvt_pk_bf16_f32 v68, v88, v89
    v_cvt_pk_bf16_f32 v69, v90, v91
    v_mfma_f32_16x16x32_bf16 v[96:99], a[96:99], a[32:35], 0
    v_cvt_pk_bf16_f32 v70, v92, v93
    v_cvt_pk_bf16_f32 v71, v94, v95
    v_mfma_f32_16x16x32_bf16 v[96:99], a[100:103], a[36:39], v[96:99]
    ds_read_b128 a[72:75], v1 offset:33792
    ds_read_b128 a[76:79], v1 offset:34304
    v_mfma_f32_16x16x32_bf16 v[96:99], a[104:107], a[40:43], v[96:99]
    v_cvt_pk_bf16_f32 v32, v32, v33
    v_cvt_pk_bf16_f32 v33, v34, v35
    v_mfma_f32_16x16x32_bf16 v[96:99], a[108:111], a[44:47], v[96:99]
    ds_read_b128 a[80:83], v1 offset:36864
    ds_read_b128 a[84:87], v1 offset:37376
    v_mfma_f32_16x16x32_bf16 v[100:103], a[112:115], a[32:35], 0
    v_cvt_pk_bf16_f32 v34, v36, v37
    v_cvt_pk_bf16_f32 v35, v38, v39
    v_mfma_f32_16x16x32_bf16 v[100:103], a[116:119], a[36:39], v[100:103]
    ds_read_b128 a[88:91], v1 offset:37888
    ds_read_b128 a[92:95], v1 offset:38400
    v_mfma_f32_16x16x32_bf16 v[100:103], a[120:123], a[40:43], v[100:103]
    v_cvt_pk_bf16_f32 v40, v40, v41
    v_cvt_pk_bf16_f32 v41, v42, v43
    v_mfma_f32_16x16x32_bf16 v[100:103], a[124:127], a[44:47], v[100:103]
    v_exp_f32 v96, v96
    v_mfma_f32_16x16x32_bf16 v[192:195], v[72:75], a[160:163], v[192:195]
    v_exp_f32 v97, v97
    v_mfma_f32_16x16x32_bf16 v[196:199], v[72:75], a[164:167], v[196:199]
    v_exp_f32 v98, v98
    v_mfma_f32_16x16x32_bf16 v[200:203], v[72:75], a[168:171], v[200:203]
    v_exp_f32 v99, v99
    v_mfma_f32_16x16x32_bf16 v[204:207], v[72:75], a[172:175], v[204:207]
    v_exp_f32 v100, v100
    v_mfma_f32_16x16x32_bf16 v[208:211], v[72:75], a[176:179], v[208:211]
    v_exp_f32 v101, v101
    v_mfma_f32_16x16x32_bf16 v[212:215], v[72:75], a[180:183], v[212:215]
    v_exp_f32 v102, v102
    v_mfma_f32_16x16x32_bf16 v[216:219], v[72:75], a[184:187], v[216:219]
    v_exp_f32 v103, v103
    v_mfma_f32_16x16x32_bf16 v[220:223], v[72:75], a[188:191], v[220:223]
    s_waitcnt vmcnt(8)
    ds_read_b128 a[32:35], v3 offset:0
    ds_read_b128 a[36:39], v3 offset:512
    v_mfma_f32_16x16x32_bf16 v[120:123], v[72:75], a[192:195], v[120:123]
    v_cvt_pk_bf16_f32 v72, v96, v97
    v_cvt_pk_bf16_f32 v73, v98, v99
    v_mfma_f32_16x16x32_bf16 v[104:107], a[96:99], a[48:51], 0
    v_cvt_pk_bf16_f32 v74, v100, v101
    v_cvt_pk_bf16_f32 v75, v102, v103
    v_mfma_f32_16x16x32_bf16 v[104:107], a[100:103], a[52:55], v[104:107]
    ds_read_b128 a[40:43], v3 offset:1024
    ds_read_b128 a[44:47], v3 offset:1536
    v_mfma_f32_16x16x32_bf16 v[104:107], a[104:107], a[56:59], v[104:107]
    v_cvt_pk_bf16_f32 v42, v44, v45
    v_cvt_pk_bf16_f32 v43, v46, v47
    v_mfma_f32_16x16x32_bf16 v[104:107], a[108:111], a[60:63], v[104:107]
    ds_read_b128 a[128:131], v2 offset:24576
    ds_read_b128 a[132:135], v2 offset:25600
    v_mfma_f32_16x16x32_bf16 v[108:111], a[112:115], a[48:51], 0
    buffer_store_dwordx4 v[32:35], v5, s[24:27], s30 offen offset:0 sc1
    v_mfma_f32_16x16x32_bf16 v[108:111], a[116:119], a[52:55], v[108:111]
    ds_read_b128 a[136:139], v2 offset:26624
    ds_read_b128 a[140:143], v2 offset:27648
    v_mfma_f32_16x16x32_bf16 v[108:111], a[120:123], a[56:59], v[108:111]
    v_cvt_pk_bf16_f32 v48, v48, v49
    v_cvt_pk_bf16_f32 v49, v50, v51
    v_mfma_f32_16x16x32_bf16 v[108:111], a[124:127], a[60:63], v[108:111]
    v_exp_f32 v104, v104
    v_mfma_f32_16x16x32_bf16 v[224:227], v[76:79], a[160:163], v[224:227]
    v_exp_f32 v105, v105
    v_mfma_f32_16x16x32_bf16 v[228:231], v[76:79], a[164:167], v[228:231]
    v_exp_f32 v106, v106
    v_mfma_f32_16x16x32_bf16 v[232:235], v[76:79], a[168:171], v[232:235]
    v_exp_f32 v107, v107
    v_mfma_f32_16x16x32_bf16 v[236:239], v[76:79], a[172:175], v[236:239]
    v_exp_f32 v108, v108
    v_mfma_f32_16x16x32_bf16 v[240:243], v[76:79], a[176:179], v[240:243]
    v_exp_f32 v109, v109
    v_mfma_f32_16x16x32_bf16 v[244:247], v[76:79], a[180:183], v[244:247]
    v_exp_f32 v110, v110
    v_mfma_f32_16x16x32_bf16 v[248:251], v[76:79], a[184:187], v[248:251]
    v_exp_f32 v111, v111
    v_mfma_f32_16x16x32_bf16 v[252:255], v[76:79], a[188:191], v[252:255]
    ds_read_b128 a[144:147], v2 offset:28672
    ds_read_b128 a[148:151], v2 offset:29696
    v_mfma_f32_16x16x32_bf16 v[124:127], v[76:79], a[192:195], v[124:127]
    v_cvt_pk_bf16_f32 v76, v104, v105
    v_cvt_pk_bf16_f32 v77, v106, v107
    v_mfma_f32_16x16x32_bf16 v[80:83], a[96:99], a[0:3], 0
    ds_read_b128 a[152:155], v2 offset:30720
    ds_read_b128 a[156:159], v2 offset:31744
    v_mfma_f32_16x16x32_bf16 v[80:83], a[100:103], a[4:7], v[80:83]
    v_cvt_pk_bf16_f32 v78, v108, v109
    v_cvt_pk_bf16_f32 v79, v110, v111
    v_mfma_f32_16x16x32_bf16 v[80:83], a[104:107], a[8:11], v[80:83]
    v_cvt_pk_bf16_f32 v50, v52, v53
    v_cvt_pk_bf16_f32 v51, v54, v55
    v_mfma_f32_16x16x32_bf16 v[80:83], a[108:111], a[12:15], v[80:83]
    buffer_store_dwordx4 v[40:43], v5, s[24:27], s30 offen offset:256 sc1
    v_mfma_f32_16x16x32_bf16 v[84:87], a[112:115], a[0:3], 0
    v_cvt_pk_bf16_f32 v56, v56, v57
    v_cvt_pk_bf16_f32 v57, v58, v59
    v_mfma_f32_16x16x32_bf16 v[84:87], a[116:119], a[4:7], v[84:87]
    v_cvt_pk_bf16_f32 v58, v60, v61
    v_cvt_pk_bf16_f32 v59, v62, v63
    v_mfma_f32_16x16x32_bf16 v[84:87], a[120:123], a[8:11], v[84:87]
    buffer_store_dwordx4 v[48:51], v5, s[24:27], s30 offen offset:512 sc1
    v_mfma_f32_16x16x32_bf16 v[84:87], a[124:127], a[12:15], v[84:87]
    v_exp_f32 v80, v80
    v_mfma_f32_16x16x32_bf16 v[128:131], v[64:67], a[160:163], v[128:131]
    v_exp_f32 v81, v81
    v_mfma_f32_16x16x32_bf16 v[132:135], v[64:67], a[164:167], v[132:135]
    v_exp_f32 v82, v82
    v_mfma_f32_16x16x32_bf16 v[136:139], v[64:67], a[168:171], v[136:139]
    v_exp_f32 v83, v83
    v_mfma_f32_16x16x32_bf16 v[140:143], v[64:67], a[172:175], v[140:143]
    v_exp_f32 v84, v84
    v_mfma_f32_16x16x32_bf16 v[144:147], v[64:67], a[176:179], v[144:147]
    v_exp_f32 v85, v85
    v_mfma_f32_16x16x32_bf16 v[148:151], v[64:67], a[180:183], v[148:151]
    v_exp_f32 v86, v86
    v_mfma_f32_16x16x32_bf16 v[152:155], v[64:67], a[184:187], v[152:155]
    v_exp_f32 v87, v87
    v_mfma_f32_16x16x32_bf16 v[156:159], v[64:67], a[188:191], v[156:159]
    v_max3_f32 v28, v28, v24, v25
    v_min3_f32 v29, v29, v24, v25
    v_mfma_f32_16x16x32_bf16 v[112:115], v[64:67], a[192:195], v[112:115]
    s_waitcnt lgkmcnt(8)
    v_cvt_pk_bf16_f32 v64, v80, v81
    v_cvt_pk_bf16_f32 v65, v82, v83
    v_mfma_f32_16x16x32_bf16 v[96:99], a[64:67], a[32:35], 0
    v_cvt_pk_bf16_f32 v66, v84, v85
    v_cvt_pk_bf16_f32 v67, v86, v87
    v_mfma_f32_16x16x32_bf16 v[96:99], a[68:71], a[36:39], v[96:99]
    s_add_u32 m0, s31, 0
    v_max3_f32 v28, v28, v26, v27
    v_min3_f32 v29, v29, v26, v27
    v_mfma_f32_16x16x32_bf16 v[96:99], a[72:75], a[40:43], v[96:99]
    buffer_store_dwordx4 v[56:59], v5, s[24:27], s30 offen offset:768 sc1
    v_mfma_f32_16x16x32_bf16 v[96:99], a[76:79], a[44:47], v[96:99]
    s_add_u32 s30, s30, 0x4000
    ds_read_b128 a[96:99], v1 offset:40960
    ds_read_b128 a[100:103], v1 offset:41472
    v_mfma_f32_16x16x32_bf16 v[100:103], a[80:83], a[32:35], 0
    buffer_load_dwordx4 v4, s[12:15], s28 offen offset:0 nt lds
    v_mfma_f32_16x16x32_bf16 v[100:103], a[84:87], a[36:39], v[100:103]
    ds_read_b128 a[104:107], v1 offset:41984
    ds_read_b128 a[108:111], v1 offset:42496
    v_mfma_f32_16x16x32_bf16 v[100:103], a[88:91], a[40:43], v[100:103]
    buffer_load_dwordx4 v4, s[12:15], s28 offen offset:2048 nt lds
    v_mfma_f32_16x16x32_bf16 v[100:103], a[92:95], a[44:47], v[100:103]
    s_waitcnt lgkmcnt(4)
    v_exp_f32 v96, v96
    v_mfma_f32_16x16x32_bf16 v[192:195], v[72:75], a[128:131], v[192:195]
    s_add_u32 m0, s31, 1024
    v_exp_f32 v97, v97
    v_mfma_f32_16x16x32_bf16 v[196:199], v[72:75], a[132:135], v[196:199]
    v_exp_f32 v98, v98
    v_mfma_f32_16x16x32_bf16 v[200:203], v[72:75], a[136:139], v[200:203]
    v_exp_f32 v99, v99
    v_mfma_f32_16x16x32_bf16 v[204:207], v[72:75], a[140:143], v[204:207]
    v_exp_f32 v100, v100
    v_mfma_f32_16x16x32_bf16 v[208:211], v[72:75], a[144:147], v[208:211]
    v_exp_f32 v101, v101
    v_mfma_f32_16x16x32_bf16 v[212:215], v[72:75], a[148:151], v[212:215]
    v_exp_f32 v102, v102
    v_mfma_f32_16x16x32_bf16 v[216:219], v[72:75], a[152:155], v[216:219]
    v_exp_f32 v103, v103
    v_mfma_f32_16x16x32_bf16 v[220:223], v[72:75], a[156:159], v[220:223]
    ds_read_b128 a[112:115], v1 offset:45056
    ds_read_b128 a[116:119], v1 offset:45568
    v_mfma_f32_16x16x32_bf16 v[120:123], v[72:75], a[192:195], v[120:123]
    v_cvt_pk_bf16_f32 v72, v96, v97
    v_cvt_pk_bf16_f32 v73, v98, v99
    v_mfma_f32_16x16x32_bf16 v[104:107], a[64:67], a[48:51], 0
    v_cvt_pk_bf16_f32 v74, v100, v101
    v_cvt_pk_bf16_f32 v75, v102, v103
    v_mfma_f32_16x16x32_bf16 v[104:107], a[68:71], a[52:55], v[104:107]
    ds_read_b128 a[120:123], v1 offset:46080
    ds_read_b128 a[124:127], v1 offset:46592
    v_mfma_f32_16x16x32_bf16 v[104:107], a[72:75], a[56:59], v[104:107]
    buffer_load_dwordx4 v4, s[12:15], s29 offen offset:0 nt lds
    v_mfma_f32_16x16x32_bf16 v[104:107], a[76:79], a[60:63], v[104:107]
    ds_read_b128 a[160:163], v2 offset:32768
    ds_read_b128 a[164:167], v2 offset:33792
    v_mfma_f32_16x16x32_bf16 v[108:111], a[80:83], a[48:51], 0
    v_rcp_f32 v24, v120
    v_mfma_f32_16x16x32_bf16 v[108:111], a[84:87], a[52:55], v[108:111]
    ds_read_b128 a[168:171], v2 offset:34816
    ds_read_b128 a[172:175], v2 offset:35840
    v_mfma_f32_16x16x32_bf16 v[108:111], a[88:91], a[56:59], v[108:111]
    v_rcp_f32 v25, v121
    v_mfma_f32_16x16x32_bf16 v[108:111], a[92:95], a[60:63], v[108:111]
    v_exp_f32 v104, v104
    v_mfma_f32_16x16x32_bf16 v[224:227], v[76:79], a[128:131], v[224:227]
    v_exp_f32 v105, v105
    v_mfma_f32_16x16x32_bf16 v[228:231], v[76:79], a[132:135], v[228:231]
    v_exp_f32 v106, v106
    v_mfma_f32_16x16x32_bf16 v[232:235], v[76:79], a[136:139], v[232:235]
    v_exp_f32 v107, v107
    v_mfma_f32_16x16x32_bf16 v[236:239], v[76:79], a[140:143], v[236:239]
    v_exp_f32 v108, v108
    v_mfma_f32_16x16x32_bf16 v[240:243], v[76:79], a[144:147], v[240:243]
    v_exp_f32 v109, v109
    v_mfma_f32_16x16x32_bf16 v[244:247], v[76:79], a[148:151], v[244:247]
    v_exp_f32 v110, v110
    v_mfma_f32_16x16x32_bf16 v[248:251], v[76:79], a[152:155], v[248:251]
    v_exp_f32 v111, v111
    v_mfma_f32_16x16x32_bf16 v[252:255], v[76:79], a[156:159], v[252:255]
    ds_read_b128 a[176:179], v2 offset:36864
    ds_read_b128 a[180:183], v2 offset:37888
    v_mfma_f32_16x16x32_bf16 v[124:127], v[76:79], a[192:195], v[124:127]
    v_cvt_pk_bf16_f32 v76, v104, v105
    v_cvt_pk_bf16_f32 v77, v106, v107
    v_mfma_f32_16x16x32_bf16 v[80:83], a[64:67], a[0:3], 0
    v_cvt_pk_bf16_f32 v78, v108, v109
    v_cvt_pk_bf16_f32 v79, v110, v111
    v_mfma_f32_16x16x32_bf16 v[80:83], a[68:71], a[4:7], v[80:83]
    ds_read_b128 a[184:187], v2 offset:38912
    ds_read_b128 a[188:191], v2 offset:39936
    v_mfma_f32_16x16x32_bf16 v[80:83], a[72:75], a[8:11], v[80:83]
    v_rcp_f32 v26, v122
    v_mfma_f32_16x16x32_bf16 v[80:83], a[76:79], a[12:15], v[80:83]
    v_rcp_f32 v27, v123
    v_mfma_f32_16x16x32_bf16 v[84:87], a[80:83], a[0:3], 0
    v_mul_f32 v32, v192, v24
    v_mul_f32 v33, v196, v24
    v_mfma_f32_16x16x32_bf16 v[84:87], a[84:87], a[4:7], v[84:87]
    v_mul_f32 v34, v200, v24
    v_mul_f32 v35, v204, v24
    v_mfma_f32_16x16x32_bf16 v[84:87], a[88:91], a[8:11], v[84:87]
    v_mul_f32 v36, v208, v24
    v_mul_f32 v37, v212, v24
    v_mfma_f32_16x16x32_bf16 v[84:87], a[92:95], a[12:15], v[84:87]
    v_exp_f32 v80, v80
    v_mfma_f32_16x16x32_bf16 v[128:131], v[64:67], a[128:131], v[128:131]
    v_exp_f32 v81, v81
    v_mfma_f32_16x16x32_bf16 v[132:135], v[64:67], a[132:135], v[132:135]
    v_exp_f32 v82, v82
    v_mfma_f32_16x16x32_bf16 v[136:139], v[64:67], a[136:139], v[136:139]
    v_exp_f32 v83, v83
    v_mfma_f32_16x16x32_bf16 v[140:143], v[64:67], a[140:143], v[140:143]
    v_exp_f32 v84, v84
    v_mfma_f32_16x16x32_bf16 v[144:147], v[64:67], a[144:147], v[144:147]
    v_exp_f32 v85, v85
    v_mfma_f32_16x16x32_bf16 v[148:151], v[64:67], a[148:151], v[148:151]
    v_exp_f32 v86, v86
    v_mfma_f32_16x16x32_bf16 v[152:155], v[64:67], a[152:155], v[152:155]
    v_exp_f32 v87, v87
    v_mfma_f32_16x16x32_bf16 v[156:159], v[64:67], a[156:159], v[156:159]
    v_mul_f32 v38, v216, v24
    v_mul_f32 v39, v220, v24
    v_mfma_f32_16x16x32_bf16 v[112:115], v[64:67], a[192:195], v[112:115]
    v_cvt_pk_bf16_f32 v64, v80, v81
    v_cvt_pk_bf16_f32 v65, v82, v83
    v_mfma_f32_16x16x32_bf16 v[88:91], a[64:67], a[16:19], 0
    v_cvt_pk_bf16_f32 v66, v84, v85
    v_cvt_pk_bf16_f32 v67, v86, v87
    v_mfma_f32_16x16x32_bf16 v[88:91], a[68:71], a[20:23], v[88:91]
    v_mul_f32 v40, v193, v25
    v_mul_f32 v41, v197, v25
    v_mfma_f32_16x16x32_bf16 v[88:91], a[72:75], a[24:27], v[88:91]
    v_mul_f32 v42, v201, v25
    v_mul_f32 v43, v205, v25
    v_mfma_f32_16x16x32_bf16 v[88:91], a[76:79], a[28:31], v[88:91]
    v_mul_f32 v44, v209, v25
    v_mul_f32 v45, v213, v25
    v_mfma_f32_16x16x32_bf16 v[92:95], a[80:83], a[16:19], 0
    v_mul_f32 v46, v217, v25
    v_mul_f32 v47, v221, v25
    v_mfma_f32_16x16x32_bf16 v[92:95], a[84:87], a[20:23], v[92:95]
    v_mul_f32 v48, v194, v26
    v_mul_f32 v49, v198, v26
    v_mfma_f32_16x16x32_bf16 v[92:95], a[88:91], a[24:27], v[92:95]
    v_mul_f32 v50, v202, v26
    v_mul_f32 v51, v206, v26
    v_mfma_f32_16x16x32_bf16 v[92:95], a[92:95], a[28:31], v[92:95]
    v_exp_f32 v88, v88
    v_mfma_f32_16x16x32_bf16 v[160:163], v[68:71], a[128:131], v[160:163]
    v_exp_f32 v89, v89
    v_mfma_f32_16x16x32_bf16 v[164:167], v[68:71], a[132:135], v[164:167]
    v_exp_f32 v90, v90
    v_mfma_f32_16x16x32_bf16 v[168:171], v[68:71], a[136:139], v[168:171]
    v_exp_f32 v91, v91
    v_mfma_f32_16x16x32_bf16 v[172:175], v[68:71], a[140:143], v[172:175]
    v_exp_f32 v92, v92
    v_mfma_f32_16x16x32_bf16 v[176:179], v[68:71], a[144:147], v[176:179]
    v_exp_f32 v93, v93
    v_mfma_f32_16x16x32_bf16 v[180:183], v[68:71], a[148:151], v[180:183]
    v_exp_f32 v94, v94
    v_mfma_f32_16x16x32_bf16 v[184:187], v[68:71], a[152:155], v[184:187]
    v_exp_f32 v95, v95
    v_mfma_f32_16x16x32_bf16 v[188:191], v[68:71], a[156:159], v[188:191]
    v_mul_f32 v52, v210, v26
    v_mul_f32 v53, v214, v26
    v_mfma_f32_16x16x32_bf16 v[116:119], v[68:71], a[192:195], v[116:119]
    s_waitcnt lgkmcnt(8)
    v_mul_f32 v54, v218, v26
    v_mul_f32 v55, v222, v26
    v_mfma_f32_16x16x32_bf16 v[96:99], a[96:99], a[32:35], 0
    v_mul_f32 v56, v195, v27
    v_mul_f32 v57, v199, v27
    v_mfma_f32_16x16x32_bf16 v[96:99], a[100:103], a[36:39], v[96:99]
    v_mul_f32 v58, v203, v27
    v_mul_f32 v59, v207, v27
    v_mfma_f32_16x16x32_bf16 v[96:99], a[104:107], a[40:43], v[96:99]
    v_mul_f32 v60, v211, v27
    v_mul_f32 v61, v215, v27
    v_mfma_f32_16x16x32_bf16 v[96:99], a[108:111], a[44:47], v[96:99]
    v_mul_f32 v62, v219, v27
    v_mul_f32 v63, v223, v27
    v_mfma_f32_16x16x32_bf16 v[100:103], a[112:115], a[32:35], 0
    v_cvt_pk_bf16_f32 v68, v88, v89
    v_cvt_pk_bf16_f32 v69, v90, v91
    v_mfma_f32_16x16x32_bf16 v[100:103], a[116:119], a[36:39], v[100:103]
    v_cvt_pk_bf16_f32 v70, v92, v93
    v_cvt_pk_bf16_f32 v71, v94, v95
    v_mfma_f32_16x16x32_bf16 v[100:103], a[120:123], a[40:43], v[100:103]
    buffer_load_dwordx4 v4, s[12:15], s29 offen offset:2048 nt lds
    v_mfma_f32_16x16x32_bf16 v[100:103], a[124:127], a[44:47], v[100:103]
    s_waitcnt lgkmcnt(0)
    v_exp_f32 v96, v96
    v_mfma_f32_16x16x32_bf16 v[192:195], v[72:75], a[160:163], 0
    s_add_u32 s28, s28, 0x4000
    v_exp_f32 v97, v97
    v_mfma_f32_16x16x32_bf16 v[196:199], v[72:75], a[164:167], 0
    s_add_u32 s29, s29, 0x4000
    v_exp_f32 v98, v98
    v_mfma_f32_16x16x32_bf16 v[200:203], v[72:75], a[168:171], 0
    v_exp_f32 v99, v99
    v_mfma_f32_16x16x32_bf16 v[204:207], v[72:75], a[172:175], 0
    v_exp_f32 v100, v100
    v_mfma_f32_16x16x32_bf16 v[208:211], v[72:75], a[176:179], 0
    v_exp_f32 v101, v101
    v_mfma_f32_16x16x32_bf16 v[212:215], v[72:75], a[180:183], 0
    v_exp_f32 v102, v102
    v_mfma_f32_16x16x32_bf16 v[216:219], v[72:75], a[184:187], 0
    v_exp_f32 v103, v103
    v_mfma_f32_16x16x32_bf16 v[220:223], v[72:75], a[188:191], 0
    ds_read_b128 a[64:67], v1 offset:49152
    ds_read_b128 a[68:71], v1 offset:49664
    v_mfma_f32_16x16x32_bf16 v[120:123], v[72:75], a[192:195], 0
    v_cvt_pk_bf16_f32 v72, v96, v97
    v_cvt_pk_bf16_f32 v73, v98, v99
    v_mfma_f32_16x16x32_bf16 v[104:107], a[96:99], a[48:51], 0
    v_cvt_pk_bf16_f32 v74, v100, v101
    v_cvt_pk_bf16_f32 v75, v102, v103
    v_mfma_f32_16x16x32_bf16 v[104:107], a[100:103], a[52:55], v[104:107]
    ds_read_b128 a[72:75], v1 offset:50176
    ds_read_b128 a[76:79], v1 offset:50688
    v_mfma_f32_16x16x32_bf16 v[104:107], a[104:107], a[56:59], v[104:107]
    v_cvt_pk_bf16_f32 v32, v32, v33
    v_cvt_pk_bf16_f32 v33, v34, v35
    v_mfma_f32_16x16x32_bf16 v[104:107], a[108:111], a[60:63], v[104:107]
    ds_read_b128 a[80:83], v1 offset:53248
    ds_read_b128 a[84:87], v1 offset:53760
    v_mfma_f32_16x16x32_bf16 v[108:111], a[112:115], a[48:51], 0
    v_cvt_pk_bf16_f32 v34, v36, v37
    v_cvt_pk_bf16_f32 v35, v38, v39
    v_mfma_f32_16x16x32_bf16 v[108:111], a[116:119], a[52:55], v[108:111]
    ds_read_b128 a[88:91], v1 offset:54272
    ds_read_b128 a[92:95], v1 offset:54784
    v_mfma_f32_16x16x32_bf16 v[108:111], a[120:123], a[56:59], v[108:111]
    v_cvt_pk_bf16_f32 v40, v40, v41
    v_cvt_pk_bf16_f32 v41, v42, v43
    v_mfma_f32_16x16x32_bf16 v[108:111], a[124:127], a[60:63], v[108:111]
    v_exp_f32 v104, v104
    v_mfma_f32_16x16x32_bf16 v[224:227], v[76:79], a[160:163], v[224:227]
    v_exp_f32 v105, v105
    v_mfma_f32_16x16x32_bf16 v[228:231], v[76:79], a[164:167], v[228:231]
    v_exp_f32 v106, v106
    v_mfma_f32_16x16x32_bf16 v[232:235], v[76:79], a[168:171], v[232:235]
    v_exp_f32 v107, v107
    v_mfma_f32_16x16x32_bf16 v[236:239], v[76:79], a[172:175], v[236:239]
    v_exp_f32 v108, v108
    v_mfma_f32_16x16x32_bf16 v[240:243], v[76:79], a[176:179], v[240:243]
    v_exp_f32 v109, v109
    v_mfma_f32_16x16x32_bf16 v[244:247], v[76:79], a[180:183], v[244:247]
    v_exp_f32 v110, v110
    v_mfma_f32_16x16x32_bf16 v[248:251], v[76:79], a[184:187], v[248:251]
    v_exp_f32 v111, v111
    v_mfma_f32_16x16x32_bf16 v[252:255], v[76:79], a[188:191], v[252:255]
    s_waitcnt vmcnt(8)
    ds_read_b128 a[48:51], v3 offset:4096
    ds_read_b128 a[52:55], v3 offset:4608
    v_mfma_f32_16x16x32_bf16 v[124:127], v[76:79], a[192:195], v[124:127]
    v_cvt_pk_bf16_f32 v76, v104, v105
    v_cvt_pk_bf16_f32 v77, v106, v107
    v_mfma_f32_16x16x32_bf16 v[80:83], a[96:99], a[0:3], 0
    v_cvt_pk_bf16_f32 v78, v108, v109
    v_cvt_pk_bf16_f32 v79, v110, v111
    v_mfma_f32_16x16x32_bf16 v[80:83], a[100:103], a[4:7], v[80:83]
    ds_read_b128 a[56:59], v3 offset:5120
    ds_read_b128 a[60:63], v3 offset:5632
    v_mfma_f32_16x16x32_bf16 v[80:83], a[104:107], a[8:11], v[80:83]
    v_cvt_pk_bf16_f32 v42, v44, v45
    v_cvt_pk_bf16_f32 v43, v46, v47
    v_mfma_f32_16x16x32_bf16 v[80:83], a[108:111], a[12:15], v[80:83]
    ds_read_b128 a[128:131], v2 offset:40960
    ds_read_b128 a[132:135], v2 offset:41984
    v_mfma_f32_16x16x32_bf16 v[84:87], a[112:115], a[0:3], 0
    buffer_store_dwordx4 v[32:35], v5, s[24:27], s30 offen offset:0 sc1
    v_mfma_f32_16x16x32_bf16 v[84:87], a[116:119], a[4:7], v[84:87]
    ds_read_b128 a[136:139], v2 offset:43008
    ds_read_b128 a[140:143], v2 offset:44032
    v_mfma_f32_16x16x32_bf16 v[84:87], a[120:123], a[8:11], v[84:87]
    v_cvt_pk_bf16_f32 v48, v48, v49
    v_cvt_pk_bf16_f32 v49, v50, v51
    v_mfma_f32_16x16x32_bf16 v[84:87], a[124:127], a[12:15], v[84:87]
    v_exp_f32 v80, v80
    v_mfma_f32_16x16x32_bf16 v[128:131], v[64:67], a[160:163], v[128:131]
    v_exp_f32 v81, v81
    v_mfma_f32_16x16x32_bf16 v[132:135], v[64:67], a[164:167], v[132:135]
    v_exp_f32 v82, v82
    v_mfma_f32_16x16x32_bf16 v[136:139], v[64:67], a[168:171], v[136:139]
    v_exp_f32 v83, v83
    v_mfma_f32_16x16x32_bf16 v[140:143], v[64:67], a[172:175], v[140:143]
    v_exp_f32 v84, v84
    v_mfma_f32_16x16x32_bf16 v[144:147], v[64:67], a[176:179], v[144:147]
    v_exp_f32 v85, v85
    v_mfma_f32_16x16x32_bf16 v[148:151], v[64:67], a[180:183], v[148:151]
    v_exp_f32 v86, v86
    v_mfma_f32_16x16x32_bf16 v[152:155], v[64:67], a[184:187], v[152:155]
    v_exp_f32 v87, v87
    v_mfma_f32_16x16x32_bf16 v[156:159], v[64:67], a[188:191], v[156:159]
    ds_read_b128 a[144:147], v2 offset:45056
    ds_read_b128 a[148:151], v2 offset:46080
    v_mfma_f32_16x16x32_bf16 v[112:115], v[64:67], a[192:195], v[112:115]
    v_cvt_pk_bf16_f32 v64, v80, v81
    v_cvt_pk_bf16_f32 v65, v82, v83
    v_mfma_f32_16x16x32_bf16 v[88:91], a[96:99], a[16:19], 0
    ds_read_b128 a[152:155], v2 offset:47104
    ds_read_b128 a[156:159], v2 offset:48128
    v_mfma_f32_16x16x32_bf16 v[88:91], a[100:103], a[20:23], v[88:91]
    v_cvt_pk_bf16_f32 v66, v84, v85
    v_cvt_pk_bf16_f32 v67, v86, v87
    v_mfma_f32_16x16x32_bf16 v[88:91], a[104:107], a[24:27], v[88:91]
    v_cvt_pk_bf16_f32 v50, v52, v53
    v_cvt_pk_bf16_f32 v51, v54, v55
    v_mfma_f32_16x16x32_bf16 v[88:91], a[108:111], a[28:31], v[88:91]
    buffer_store_dwordx4 v[40:43], v5, s[24:27], s30 offen offset:256 sc1
    v_mfma_f32_16x16x32_bf16 v[92:95], a[112:115], a[16:19], 0
    v_cvt_pk_bf16_f32 v56, v56, v57
    v_cvt_pk_bf16_f32 v57, v58, v59
    v_mfma_f32_16x16x32_bf16 v[92:95], a[116:119], a[20:23], v[92:95]
    v_cvt_pk_bf16_f32 v58, v60, v61
    v_cvt_pk_bf16_f32 v59, v62, v63
    v_mfma_f32_16x16x32_bf16 v[92:95], a[120:123], a[24:27], v[92:95]
    buffer_store_dwordx4 v[48:51], v5, s[24:27], s30 offen offset:512 sc1
    v_mfma_f32_16x16x32_bf16 v[92:95], a[124:127], a[28:31], v[92:95]
    v_exp_f32 v88, v88
    v_mfma_f32_16x16x32_bf16 v[160:163], v[68:71], a[160:163], v[160:163]
    v_exp_f32 v89, v89
    v_mfma_f32_16x16x32_bf16 v[164:167], v[68:71], a[164:167], v[164:167]
    v_exp_f32 v90, v90
    v_mfma_f32_16x16x32_bf16 v[168:171], v[68:71], a[168:171], v[168:171]
    v_exp_f32 v91, v91
    v_mfma_f32_16x16x32_bf16 v[172:175], v[68:71], a[172:175], v[172:175]
    v_exp_f32 v92, v92
    v_mfma_f32_16x16x32_bf16 v[176:179], v[68:71], a[176:179], v[176:179]
    v_exp_f32 v93, v93
    v_mfma_f32_16x16x32_bf16 v[180:183], v[68:71], a[180:183], v[180:183]
    v_exp_f32 v94, v94
    v_mfma_f32_16x16x32_bf16 v[184:187], v[68:71], a[184:187], v[184:187]
    v_exp_f32 v95, v95
    v_mfma_f32_16x16x32_bf16 v[188:191], v[68:71], a[188:191], v[188:191]
    v_max3_f32 v28, v28, v24, v25
    v_min3_f32 v29, v29, v24, v25
    v_mfma_f32_16x16x32_bf16 v[116:119], v[68:71], a[192:195], v[116:119]
    s_waitcnt lgkmcnt(8)
    v_cvt_pk_bf16_f32 v68, v88, v89
    v_cvt_pk_bf16_f32 v69, v90, v91
    v_mfma_f32_16x16x32_bf16 v[104:107], a[64:67], a[48:51], 0
    v_cvt_pk_bf16_f32 v70, v92, v93
    v_cvt_pk_bf16_f32 v71, v94, v95
    v_mfma_f32_16x16x32_bf16 v[104:107], a[68:71], a[52:55], v[104:107]
    s_add_u32 m0, s31, 4096
    v_max3_f32 v28, v28, v26, v27
    v_min3_f32 v29, v29, v26, v27
    v_mfma_f32_16x16x32_bf16 v[104:107], a[72:75], a[56:59], v[104:107]
    buffer_store_dwordx4 v[56:59], v5, s[24:27], s30 offen offset:768 sc1
    v_mfma_f32_16x16x32_bf16 v[104:107], a[76:79], a[60:63], v[104:107]
    s_add_u32 s30, s30, 0x4000
    ds_read_b128 a[96:99], v1 offset:57344
    ds_read_b128 a[100:103], v1 offset:57856
    v_mfma_f32_16x16x32_bf16 v[108:111], a[80:83], a[48:51], 0
    buffer_load_dwordx4 v4, s[12:15], s28 offen offset:0 nt lds
    v_mfma_f32_16x16x32_bf16 v[108:111], a[84:87], a[52:55], v[108:111]
    ds_read_b128 a[104:107], v1 offset:58368
    ds_read_b128 a[108:111], v1 offset:58880
    v_mfma_f32_16x16x32_bf16 v[108:111], a[88:91], a[56:59], v[108:111]
    buffer_load_dwordx4 v4, s[12:15], s28 offen offset:2048 nt lds
    v_mfma_f32_16x16x32_bf16 v[108:111], a[92:95], a[60:63], v[108:111]
    s_waitcnt lgkmcnt(4)
    v_exp_f32 v104, v104
    v_mfma_f32_16x16x32_bf16 v[224:227], v[76:79], a[128:131], v[224:227]
    s_add_u32 m0, s31, 5120
    v_exp_f32 v105, v105
    v_mfma_f32_16x16x32_bf16 v[228:231], v[76:79], a[132:135], v[228:231]
    v_exp_f32 v106, v106
    v_mfma_f32_16x16x32_bf16 v[232:235], v[76:79], a[136:139], v[232:235]
    v_exp_f32 v107, v107
    v_mfma_f32_16x16x32_bf16 v[236:239], v[76:79], a[140:143], v[236:239]
    v_exp_f32 v108, v108
    v_mfma_f32_16x16x32_bf16 v[240:243], v[76:79], a[144:147], v[240:243]
    v_exp_f32 v109, v109
    v_mfma_f32_16x16x32_bf16 v[244:247], v[76:79], a[148:151], v[244:247]
    v_exp_f32 v110, v110
    v_mfma_f32_16x16x32_bf16 v[248:251], v[76:79], a[152:155], v[248:251]
    v_exp_f32 v111, v111
    v_mfma_f32_16x16x32_bf16 v[252:255], v[76:79], a[156:159], v[252:255]
    ds_read_b128 a[112:115], v1 offset:61440
    ds_read_b128 a[116:119], v1 offset:61952
    v_mfma_f32_16x16x32_bf16 v[124:127], v[76:79], a[192:195], v[124:127]
    v_cvt_pk_bf16_f32 v76, v104, v105
    v_cvt_pk_bf16_f32 v77, v106, v107
    v_mfma_f32_16x16x32_bf16 v[80:83], a[64:67], a[0:3], 0
    v_cvt_pk_bf16_f32 v78, v108, v109
    v_cvt_pk_bf16_f32 v79, v110, v111
    v_mfma_f32_16x16x32_bf16 v[80:83], a[68:71], a[4:7], v[80:83]
    ds_read_b128 a[120:123], v1 offset:62464
    ds_read_b128 a[124:127], v1 offset:62976
    v_mfma_f32_16x16x32_bf16 v[80:83], a[72:75], a[8:11], v[80:83]
    buffer_load_dwordx4 v4, s[12:15], s29 offen offset:0 nt lds
    v_mfma_f32_16x16x32_bf16 v[80:83], a[76:79], a[12:15], v[80:83]
    ds_read_b128 a[160:163], v2 offset:49152
    ds_read_b128 a[164:167], v2 offset:50176
    v_mfma_f32_16x16x32_bf16 v[84:87], a[80:83], a[0:3], 0
    v_rcp_f32 v24, v124
    v_mfma_f32_16x16x32_bf16 v[84:87], a[84:87], a[4:7], v[84:87]
    ds_read_b128 a[168:171], v2 offset:51200
    ds_read_b128 a[172:175], v2 offset:52224
    v_mfma_f32_16x16x32_bf16 v[84:87], a[88:91], a[8:11], v[84:87]
    v_rcp_f32 v25, v125
    v_mfma_f32_16x16x32_bf16 v[84:87], a[92:95], a[12:15], v[84:87]
    v_exp_f32 v80, v80
    v_mfma_f32_16x16x32_bf16 v[128:131], v[64:67], a[128:131], v[128:131]
    v_exp_f32 v81, v81
    v_mfma_f32_16x16x32_bf16 v[132:135], v[64:67], a[132:135], v[132:135]
    v_exp_f32 v82, v82
    v_mfma_f32_16x16x32_bf16 v[136:139], v[64:67], a[136:139], v[136:139]
    v_exp_f32 v83, v83
    v_mfma_f32_16x16x32_bf16 v[140:143], v[64:67], a[140:143], v[140:143]
    v_exp_f32 v84, v84
    v_mfma_f32_16x16x32_bf16 v[144:147], v[64:67], a[144:147], v[144:147]
    v_exp_f32 v85, v85
    v_mfma_f32_16x16x32_bf16 v[148:151], v[64:67], a[148:151], v[148:151]
    v_exp_f32 v86, v86
    v_mfma_f32_16x16x32_bf16 v[152:155], v[64:67], a[152:155], v[152:155]
    v_exp_f32 v87, v87
    v_mfma_f32_16x16x32_bf16 v[156:159], v[64:67], a[156:159], v[156:159]
    ds_read_b128 a[176:179], v2 offset:53248
    ds_read_b128 a[180:183], v2 offset:54272
    v_mfma_f32_16x16x32_bf16 v[112:115], v[64:67], a[192:195], v[112:115]
    v_cvt_pk_bf16_f32 v64, v80, v81
    v_cvt_pk_bf16_f32 v65, v82, v83
    v_mfma_f32_16x16x32_bf16 v[88:91], a[64:67], a[16:19], 0
    v_cvt_pk_bf16_f32 v66, v84, v85
    v_cvt_pk_bf16_f32 v67, v86, v87
    v_mfma_f32_16x16x32_bf16 v[88:91], a[68:71], a[20:23], v[88:91]
    ds_read_b128 a[184:187], v2 offset:55296
    ds_read_b128 a[188:191], v2 offset:56320
    v_mfma_f32_16x16x32_bf16 v[88:91], a[72:75], a[24:27], v[88:91]
    v_rcp_f32 v26, v126
    v_mfma_f32_16x16x32_bf16 v[88:91], a[76:79], a[28:31], v[88:91]
    v_rcp_f32 v27, v127
    v_mfma_f32_16x16x32_bf16 v[92:95], a[80:83], a[16:19], 0
    v_mul_f32 v32, v224, v24
    v_mul_f32 v33, v228, v24
    v_mfma_f32_16x16x32_bf16 v[92:95], a[84:87], a[20:23], v[92:95]
    v_mul_f32 v34, v232, v24
    v_mul_f32 v35, v236, v24
    v_mfma_f32_16x16x32_bf16 v[92:95], a[88:91], a[24:27], v[92:95]
    v_mul_f32 v36, v240, v24
    v_mul_f32 v37, v244, v24
    v_mfma_f32_16x16x32_bf16 v[92:95], a[92:95], a[28:31], v[92:95]
    v_exp_f32 v88, v88
    v_mfma_f32_16x16x32_bf16 v[160:163], v[68:71], a[128:131], v[160:163]
    v_exp_f32 v89, v89
    v_mfma_f32_16x16x32_bf16 v[164:167], v[68:71], a[132:135], v[164:167]
    v_exp_f32 v90, v90
    v_mfma_f32_16x16x32_bf16 v[168:171], v[68:71], a[136:139], v[168:171]
    v_exp_f32 v91, v91
    v_mfma_f32_16x16x32_bf16 v[172:175], v[68:71], a[140:143], v[172:175]
    v_exp_f32 v92, v92
    v_mfma_f32_16x16x32_bf16 v[176:179], v[68:71], a[144:147], v[176:179]
    v_exp_f32 v93, v93
    v_mfma_f32_16x16x32_bf16 v[180:183], v[68:71], a[148:151], v[180:183]
    v_exp_f32 v94, v94
    v_mfma_f32_16x16x32_bf16 v[184:187], v[68:71], a[152:155], v[184:187]
    v_exp_f32 v95, v95
    v_mfma_f32_16x16x32_bf16 v[188:191], v[68:71], a[156:159], v[188:191]
    v_mul_f32 v38, v248, v24
    v_mul_f32 v39, v252, v24
    v_mfma_f32_16x16x32_bf16 v[116:119], v[68:71], a[192:195], v[116:119]
    v_cvt_pk_bf16_f32 v68, v88, v89
    v_cvt_pk_bf16_f32 v69, v90, v91
    v_mfma_f32_16x16x32_bf16 v[96:99], a[64:67], a[32:35], 0
    v_cvt_pk_bf16_f32 v70, v92, v93
    v_cvt_pk_bf16_f32 v71, v94, v95
    v_mfma_f32_16x16x32_bf16 v[96:99], a[68:71], a[36:39], v[96:99]
    v_mul_f32 v40, v225, v25
    v_mul_f32 v41, v229, v25
    v_mfma_f32_16x16x32_bf16 v[96:99], a[72:75], a[40:43], v[96:99]
    v_mul_f32 v42, v233, v25
    v_mul_f32 v43, v237, v25
    v_mfma_f32_16x16x32_bf16 v[96:99], a[76:79], a[44:47], v[96:99]
    v_mul_f32 v44, v241, v25
    v_mul_f32 v45, v245, v25
    v_mfma_f32_16x16x32_bf16 v[100:103], a[80:83], a[32:35], 0
    v_mul_f32 v46, v249, v25
    v_mul_f32 v47, v253, v25
    v_mfma_f32_16x16x32_bf16 v[100:103], a[84:87], a[36:39], v[100:103]
    v_mul_f32 v48, v226, v26
    v_mul_f32 v49, v230, v26
    v_mfma_f32_16x16x32_bf16 v[100:103], a[88:91], a[40:43], v[100:103]
    v_mul_f32 v50, v234, v26
    v_mul_f32 v51, v238, v26
    v_mfma_f32_16x16x32_bf16 v[100:103], a[92:95], a[44:47], v[100:103]
    v_exp_f32 v96, v96
    v_mfma_f32_16x16x32_bf16 v[192:195], v[72:75], a[128:131], v[192:195]
    v_exp_f32 v97, v97
    v_mfma_f32_16x16x32_bf16 v[196:199], v[72:75], a[132:135], v[196:199]
    v_exp_f32 v98, v98
    v_mfma_f32_16x16x32_bf16 v[200:203], v[72:75], a[136:139], v[200:203]
    v_exp_f32 v99, v99
    v_mfma_f32_16x16x32_bf16 v[204:207], v[72:75], a[140:143], v[204:207]
    v_exp_f32 v100, v100
    v_mfma_f32_16x16x32_bf16 v[208:211], v[72:75], a[144:147], v[208:211]
    v_exp_f32 v101, v101
    v_mfma_f32_16x16x32_bf16 v[212:215], v[72:75], a[148:151], v[212:215]
    v_exp_f32 v102, v102
    v_mfma_f32_16x16x32_bf16 v[216:219], v[72:75], a[152:155], v[216:219]
    v_exp_f32 v103, v103
    v_mfma_f32_16x16x32_bf16 v[220:223], v[72:75], a[156:159], v[220:223]
    v_mul_f32 v52, v242, v26
    v_mul_f32 v53, v246, v26
    v_mfma_f32_16x16x32_bf16 v[120:123], v[72:75], a[192:195], v[120:123]
    s_waitcnt lgkmcnt(8)
    v_mul_f32 v54, v250, v26
    v_mul_f32 v55, v254, v26
    v_mfma_f32_16x16x32_bf16 v[104:107], a[96:99], a[48:51], 0
    v_mul_f32 v56, v227, v27
    v_mul_f32 v57, v231, v27
    v_mfma_f32_16x16x32_bf16 v[104:107], a[100:103], a[52:55], v[104:107]
    v_mul_f32 v58, v235, v27
    v_mul_f32 v59, v239, v27
    v_mfma_f32_16x16x32_bf16 v[104:107], a[104:107], a[56:59], v[104:107]
    v_mul_f32 v60, v243, v27
    v_mul_f32 v61, v247, v27
    v_mfma_f32_16x16x32_bf16 v[104:107], a[108:111], a[60:63], v[104:107]
    v_mul_f32 v62, v251, v27
    v_mul_f32 v63, v255, v27
    v_mfma_f32_16x16x32_bf16 v[108:111], a[112:115], a[48:51], 0
    v_cvt_pk_bf16_f32 v72, v96, v97
    v_cvt_pk_bf16_f32 v73, v98, v99
    v_mfma_f32_16x16x32_bf16 v[108:111], a[116:119], a[52:55], v[108:111]
    v_cvt_pk_bf16_f32 v74, v100, v101
    v_cvt_pk_bf16_f32 v75, v102, v103
    v_mfma_f32_16x16x32_bf16 v[108:111], a[120:123], a[56:59], v[108:111]
    buffer_load_dwordx4 v4, s[12:15], s29 offen offset:2048 nt lds
    v_mfma_f32_16x16x32_bf16 v[108:111], a[124:127], a[60:63], v[108:111]
    s_waitcnt lgkmcnt(0)
    v_exp_f32 v104, v104
    v_mfma_f32_16x16x32_bf16 v[224:227], v[76:79], a[160:163], 0
    s_add_u32 s28, s28, 0x4000
    v_exp_f32 v105, v105
    v_mfma_f32_16x16x32_bf16 v[228:231], v[76:79], a[164:167], 0
    s_add_u32 s29, s29, 0x4000
    v_exp_f32 v106, v106
    v_mfma_f32_16x16x32_bf16 v[232:235], v[76:79], a[168:171], 0
    v_exp_f32 v107, v107
    v_mfma_f32_16x16x32_bf16 v[236:239], v[76:79], a[172:175], 0
    v_exp_f32 v108, v108
    v_mfma_f32_16x16x32_bf16 v[240:243], v[76:79], a[176:179], 0
    v_exp_f32 v109, v109
    v_mfma_f32_16x16x32_bf16 v[244:247], v[76:79], a[180:183], 0
    v_exp_f32 v110, v110
    v_mfma_f32_16x16x32_bf16 v[248:251], v[76:79], a[184:187], 0
    v_exp_f32 v111, v111
    v_mfma_f32_16x16x32_bf16 v[252:255], v[76:79], a[188:191], 0
    ds_read_b128 a[64:67], v1 offset:0
    ds_read_b128 a[68:71], v1 offset:512
    v_mfma_f32_16x16x32_bf16 v[124:127], v[76:79], a[192:195], 0
    v_cvt_pk_bf16_f32 v76, v104, v105
    v_cvt_pk_bf16_f32 v77, v106, v107
    v_mfma_f32_16x16x32_bf16 v[80:83], a[96:99], a[0:3], 0
    v_cvt_pk_bf16_f32 v78, v108, v109
    v_cvt_pk_bf16_f32 v79, v110, v111
    v_mfma_f32_16x16x32_bf16 v[80:83], a[100:103], a[4:7], v[80:83]
    ds_read_b128 a[72:75], v1 offset:1024
    ds_read_b128 a[76:79], v1 offset:1536
    v_mfma_f32_16x16x32_bf16 v[80:83], a[104:107], a[8:11], v[80:83]
    v_cvt_pk_bf16_f32 v32, v32, v33
    v_cvt_pk_bf16_f32 v33, v34, v35
    v_mfma_f32_16x16x32_bf16 v[80:83], a[108:111], a[12:15], v[80:83]
    ds_read_b128 a[80:83], v1 offset:4096
    ds_read_b128 a[84:87], v1 offset:4608
    v_mfma_f32_16x16x32_bf16 v[84:87], a[112:115], a[0:3], 0
    v_cvt_pk_bf16_f32 v34, v36, v37
    v_cvt_pk_bf16_f32 v35, v38, v39
    v_mfma_f32_16x16x32_bf16 v[84:87], a[116:119], a[4:7], v[84:87]
    ds_read_b128 a[88:91], v1 offset:5120
    ds_read_b128 a[92:95], v1 offset:5632
    v_mfma_f32_16x16x32_bf16 v[84:87], a[120:123], a[8:11], v[84:87]
    v_cvt_pk_bf16_f32 v40, v40, v41
    v_cvt_pk_bf16_f32 v41, v42, v43
    v_mfma_f32_16x16x32_bf16 v[84:87], a[124:127], a[12:15], v[84:87]
    v_exp_f32 v80, v80
    v_mfma_f32_16x16x32_bf16 v[128:131], v[64:67], a[160:163], v[128:131]
    v_exp_f32 v81, v81
    v_mfma_f32_16x16x32_bf16 v[132:135], v[64:67], a[164:167], v[132:135]
    v_exp_f32 v82, v82
    v_mfma_f32_16x16x32_bf16 v[136:139], v[64:67], a[168:171], v[136:139]
    s_waitcnt vmcnt(8)
    ds_read_b128 a[0:3], v3 offset:0
    v_exp_f32 v83, v83
    v_mfma_f32_16x16x32_bf16 v[140:143], v[64:67], a[172:175], v[140:143]
    v_exp_f32 v84, v84
    v_cvt_pk_bf16_f32 v42, v44, v45
    v_mfma_f32_16x16x32_bf16 v[144:147], v[64:67], a[176:179], v[144:147]
    ds_read_b128 a[4:7], v3 offset:512
    v_exp_f32 v85, v85
    v_mfma_f32_16x16x32_bf16 v[148:151], v[64:67], a[180:183], v[148:151]
    v_exp_f32 v86, v86
    v_mfma_f32_16x16x32_bf16 v[152:155], v[64:67], a[184:187], v[152:155]
    v_exp_f32 v87, v87
    v_mfma_f32_16x16x32_bf16 v[156:159], v[64:67], a[188:191], v[156:159]
    ds_read_b128 a[8:11], v3 offset:1024
    ds_read_b128 a[12:15], v3 offset:1536
    v_mfma_f32_16x16x32_bf16 v[112:115], v[64:67], a[192:195], v[112:115]
    v_cvt_pk_bf16_f32 v64, v80, v81
    v_cvt_pk_bf16_f32 v65, v82, v83
    v_mfma_f32_16x16x32_bf16 v[88:91], a[96:99], a[16:19], 0
    v_cvt_pk_bf16_f32 v66, v84, v85
    v_cvt_pk_bf16_f32 v67, v86, v87
    v_mfma_f32_16x16x32_bf16 v[88:91], a[100:103], a[20:23], v[88:91]
    ds_read_b128 a[128:131], v2 offset:57344
    ds_read_b128 a[132:135], v2 offset:58368
    v_mfma_f32_16x16x32_bf16 v[88:91], a[104:107], a[24:27], v[88:91]
    v_cvt_pk_bf16_f32 v43, v46, v47
    v_mfma_f32_16x16x32_bf16 v[88:91], a[108:111], a[28:31], v[88:91]
    ds_read_b128 a[136:139], v2 offset:59392
    ds_read_b128 a[140:143], v2 offset:60416
    v_mfma_f32_16x16x32_bf16 v[92:95], a[112:115], a[16:19], 0
    buffer_store_dwordx4 v[32:35], v5, s[24:27], s30 offen offset:0 sc1
    v_cvt_pk_bf16_f32 v48, v48, v49
    v_mfma_f32_16x16x32_bf16 v[92:95], a[116:119], a[20:23], v[92:95]
    ds_read_b128 a[144:147], v2 offset:61440
    ds_read_b128 a[148:151], v2 offset:62464
    v_mfma_f32_16x16x32_bf16 v[92:95], a[120:123], a[24:27], v[92:95]
    v_cvt_pk_bf16_f32 v49, v50, v51
    v_cvt_pk_bf16_f32 v50, v52, v53
    v_mfma_f32_16x16x32_bf16 v[92:95], a[124:127], a[28:31], v[92:95]
    v_exp_f32 v88, v88
    v_mfma_f32_16x16x32_bf16 v[160:163], v[68:71], a[160:163], v[160:163]
    v_exp_f32 v89, v89
    v_mfma_f32_16x16x32_bf16 v[164:167], v[68:71], a[164:167], v[164:167]
    v_exp_f32 v90, v90
    v_mfma_f32_16x16x32_bf16 v[168:171], v[68:71], a[168:171], v[168:171]
    v_exp_f32 v91, v91
    v_mfma_f32_16x16x32_bf16 v[172:175], v[68:71], a[172:175], v[172:175]
    v_exp_f32 v92, v92
    v_mfma_f32_16x16x32_bf16 v[176:179], v[68:71], a[176:179], v[176:179]
    v_exp_f32 v93, v93
    v_mfma_f32_16x16x32_bf16 v[180:183], v[68:71], a[180:183], v[180:183]
    v_exp_f32 v94, v94
    v_mfma_f32_16x16x32_bf16 v[184:187], v[68:71], a[184:187], v[184:187]
    v_exp_f32 v95, v95
    v_mfma_f32_16x16x32_bf16 v[188:191], v[68:71], a[188:191], v[188:191]
    ds_read_b128 a[152:155], v2 offset:63488
    ds_read_b128 a[156:159], v2 offset:64512
    v_mfma_f32_16x16x32_bf16 v[116:119], v[68:71], a[192:195], v[116:119]
    v_cvt_pk_bf16_f32 v68, v88, v89
    v_cvt_pk_bf16_f32 v69, v90, v91
    v_mfma_f32_16x16x32_bf16 v[96:99], a[96:99], a[32:35], 0
    v_cvt_pk_bf16_f32 v70, v92, v93
    v_cvt_pk_bf16_f32 v71, v94, v95
    v_mfma_f32_16x16x32_bf16 v[96:99], a[100:103], a[36:39], v[96:99]
    v_cvt_pk_bf16_f32 v51, v54, v55
    v_mfma_f32_16x16x32_bf16 v[96:99], a[104:107], a[40:43], v[96:99]
    buffer_store_dwordx4 v[40:43], v5, s[24:27], s30 offen offset:256 sc1
    v_cvt_pk_bf16_f32 v56, v56, v57
    v_mfma_f32_16x16x32_bf16 v[96:99], a[108:111], a[44:47], v[96:99]
    v_cvt_pk_bf16_f32 v57, v58, v59
    v_cvt_pk_bf16_f32 v58, v60, v61
    v_mfma_f32_16x16x32_bf16 v[100:103], a[112:115], a[32:35], 0
    v_cvt_pk_bf16_f32 v59, v62, v63
    v_mfma_f32_16x16x32_bf16 v[100:103], a[116:119], a[36:39], v[100:103]
    buffer_store_dwordx4 v[48:51], v5, s[24:27], s30 offen offset:512 sc1
    v_max3_f32 v28, v28, v24, v25
    v_mfma_f32_16x16x32_bf16 v[100:103], a[120:123], a[40:43], v[100:103]
    v_min3_f32 v29, v29, v24, v25
    v_max3_f32 v28, v28, v26, v27
    v_mfma_f32_16x16x32_bf16 v[100:103], a[124:127], a[44:47], v[100:103]
    v_exp_f32 v96, v96
    v_mfma_f32_16x16x32_bf16 v[192:195], v[72:75], a[160:163], v[192:195]
    v_exp_f32 v97, v97
    v_mfma_f32_16x16x32_bf16 v[196:199], v[72:75], a[164:167], v[196:199]
    v_exp_f32 v98, v98
    v_mfma_f32_16x16x32_bf16 v[200:203], v[72:75], a[168:171], v[200:203]
    v_exp_f32 v99, v99
    v_mfma_f32_16x16x32_bf16 v[204:207], v[72:75], a[172:175], v[204:207]
    v_exp_f32 v100, v100
    v_mfma_f32_16x16x32_bf16 v[208:211], v[72:75], a[176:179], v[208:211]
    v_exp_f32 v101, v101
    v_mfma_f32_16x16x32_bf16 v[212:215], v[72:75], a[180:183], v[212:215]
    v_exp_f32 v102, v102
    v_mfma_f32_16x16x32_bf16 v[216:219], v[72:75], a[184:187], v[216:219]
    v_exp_f32 v103, v103
    v_mfma_f32_16x16x32_bf16 v[220:223], v[72:75], a[188:191], v[220:223]
    v_min3_f32 v29, v29, v26, v27
    v_mfma_f32_16x16x32_bf16 v[120:123], v[72:75], a[192:195], v[120:123]
    buffer_store_dwordx4 v[56:59], v5, s[24:27], s30 offen offset:768 sc1
    s_add_u32 s30, s30, 0x4000
    s_add_u32 s32, s32, 1
    s_cmp_lt_u32 s32, 3
    s_cbranch_scc1 L_loop
    s_waitcnt lgkmcnt(0)
    v_mfma_f32_16x16x32_bf16 v[128:131], v[64:67], a[128:131], v[128:131]
    v_cvt_pk_bf16_f32 v72, v96, v97
    v_cvt_pk_bf16_f32 v73, v98, v99
    v_mfma_f32_16x16x32_bf16 v[132:135], v[64:67], a[132:135], v[132:135]
    v_cvt_pk_bf16_f32 v74, v100, v101
    v_cvt_pk_bf16_f32 v75, v102, v103
    v_mfma_f32_16x16x32_bf16 v[136:139], v[64:67], a[136:139], v[136:139]
    ds_read_b128 a[96:99], v1 offset:8192
    ds_read_b128 a[100:103], v1 offset:8704
    v_mfma_f32_16x16x32_bf16 v[140:143], v[64:67], a[140:143], v[140:143]
    v_mfma_f32_16x16x32_bf16 v[144:147], v[64:67], a[144:147], v[144:147]
    ds_read_b128 a[104:107], v1 offset:9216
    ds_read_b128 a[108:111], v1 offset:9728
    v_mfma_f32_16x16x32_bf16 v[148:151], v[64:67], a[148:151], v[148:151]
    v_mfma_f32_16x16x32_bf16 v[152:155], v[64:67], a[152:155], v[152:155]
    ds_read_b128 a[112:115], v1 offset:12288
    ds_read_b128 a[116:119], v1 offset:12800
    v_mfma_f32_16x16x32_bf16 v[156:159], v[64:67], a[156:159], v[156:159]
    v_mfma_f32_16x16x32_bf16 v[112:115], v[64:67], a[192:195], v[112:115]
    ds_read_b128 a[120:123], v1 offset:13312
    ds_read_b128 a[124:127], v1 offset:13824
    v_mfma_f32_16x16x32_bf16 v[88:91], a[64:67], a[16:19], 0
    v_mfma_f32_16x16x32_bf16 v[88:91], a[68:71], a[20:23], v[88:91]
    ds_read_b128 a[160:163], v2 offset:0
    ds_read_b128 a[164:167], v2 offset:1024
    v_mfma_f32_16x16x32_bf16 v[88:91], a[72:75], a[24:27], v[88:91]
    v_mfma_f32_16x16x32_bf16 v[88:91], a[76:79], a[28:31], v[88:91]
    ds_read_b128 a[168:171], v2 offset:2048
    ds_read_b128 a[172:175], v2 offset:3072
    v_mfma_f32_16x16x32_bf16 v[92:95], a[80:83], a[16:19], 0
    v_rcp_f32 v24, v112
    v_mfma_f32_16x16x32_bf16 v[92:95], a[84:87], a[20:23], v[92:95]
    ds_read_b128 a[176:179], v2 offset:4096
    ds_read_b128 a[180:183], v2 offset:5120
    v_mfma_f32_16x16x32_bf16 v[92:95], a[88:91], a[24:27], v[92:95]
    v_rcp_f32 v25, v113
    v_mfma_f32_16x16x32_bf16 v[92:95], a[92:95], a[28:31], v[92:95]
    v_exp_f32 v88, v88
    v_mfma_f32_16x16x32_bf16 v[160:163], v[68:71], a[128:131], v[160:163]
    v_exp_f32 v89, v89
    v_mfma_f32_16x16x32_bf16 v[164:167], v[68:71], a[132:135], v[164:167]
    v_exp_f32 v90, v90
    v_mfma_f32_16x16x32_bf16 v[168:171], v[68:71], a[136:139], v[168:171]
    v_exp_f32 v91, v91
    v_mfma_f32_16x16x32_bf16 v[172:175], v[68:71], a[140:143], v[172:175]
    v_exp_f32 v92, v92
    v_mfma_f32_16x16x32_bf16 v[176:179], v[68:71], a[144:147], v[176:179]
    v_exp_f32 v93, v93
    v_mfma_f32_16x16x32_bf16 v[180:183], v[68:71], a[148:151], v[180:183]
    v_exp_f32 v94, v94
    v_mfma_f32_16x16x32_bf16 v[184:187], v[68:71], a[152:155], v[184:187]
    v_exp_f32 v95, v95
    v_mfma_f32_16x16x32_bf16 v[188:191], v[68:71], a[156:159], v[188:191]
    ds_read_b128 a[184:187], v2 offset:6144
    ds_read_b128 a[188:191], v2 offset:7168
    v_mfma_f32_16x16x32_bf16 v[116:119], v[68:71], a[192:195], v[116:119]
    v_cvt_pk_bf16_f32 v68, v88, v89
    v_cvt_pk_bf16_f32 v69, v90, v91
    v_mfma_f32_16x16x32_bf16 v[96:99], a[64:67], a[32:35], 0
    v_cvt_pk_bf16_f32 v70, v92, v93
    v_cvt_pk_bf16_f32 v71, v94, v95
    v_mfma_f32_16x16x32_bf16 v[96:99], a[68:71], a[36:39], v[96:99]
    v_rcp_f32 v26, v114
    v_mfma_f32_16x16x32_bf16 v[96:99], a[72:75], a[40:43], v[96:99]
    v_rcp_f32 v27, v115
    v_mfma_f32_16x16x32_bf16 v[96:99], a[76:79], a[44:47], v[96:99]
    v_mul_f32 v32, v128, v24
    v_mul_f32 v33, v132, v24
    v_mfma_f32_16x16x32_bf16 v[100:103], a[80:83], a[32:35], 0
    v_mul_f32 v34, v136, v24
    v_mul_f32 v35, v140, v24
    v_mfma_f32_16x16x32_bf16 v[100:103], a[84:87], a[36:39], v[100:103]
    v_mul_f32 v36, v144, v24
    v_mul_f32 v37, v148, v24
    v_mfma_f32_16x16x32_bf16 v[100:103], a[88:91], a[40:43], v[100:103]
    v_mul_f32 v38, v152, v24
    v_mul_f32 v39, v156, v24
    v_mfma_f32_16x16x32_bf16 v[100:103], a[92:95], a[44:47], v[100:103]
    v_exp_f32 v96, v96
    v_mfma_f32_16x16x32_bf16 v[192:195], v[72:75], a[128:131], v[192:195]
    v_exp_f32 v97, v97
    v_mfma_f32_16x16x32_bf16 v[196:199], v[72:75], a[132:135], v[196:199]
    v_exp_f32 v98, v98
    v_mfma_f32_16x16x32_bf16 v[200:203], v[72:75], a[136:139], v[200:203]
    v_exp_f32 v99, v99
    v_mfma_f32_16x16x32_bf16 v[204:207], v[72:75], a[140:143], v[204:207]
    v_exp_f32 v100, v100
    v_mfma_f32_16x16x32_bf16 v[208:211], v[72:75], a[144:147], v[208:211]
    v_exp_f32 v101, v101
    v_mfma_f32_16x16x32_bf16 v[212:215], v[72:75], a[148:151], v[212:215]
    v_exp_f32 v102, v102
    v_mfma_f32_16x16x32_bf16 v[216:219], v[72:75], a[152:155], v[216:219]
    v_exp_f32 v103, v103
    v_mfma_f32_16x16x32_bf16 v[220:223], v[72:75], a[156:159], v[220:223]
    v_mul_f32 v40, v129, v25
    v_mul_f32 v41, v133, v25
    v_mfma_f32_16x16x32_bf16 v[120:123], v[72:75], a[192:195], v[120:123]
    v_cvt_pk_bf16_f32 v72, v96, v97
    v_cvt_pk_bf16_f32 v73, v98, v99
    v_mfma_f32_16x16x32_bf16 v[104:107], a[64:67], a[48:51], 0
    v_cvt_pk_bf16_f32 v74, v100, v101
    v_cvt_pk_bf16_f32 v75, v102, v103
    v_mfma_f32_16x16x32_bf16 v[104:107], a[68:71], a[52:55], v[104:107]
    v_mul_f32 v42, v137, v25
    v_mul_f32 v43, v141, v25
    v_mfma_f32_16x16x32_bf16 v[104:107], a[72:75], a[56:59], v[104:107]
    v_mul_f32 v44, v145, v25
    v_mul_f32 v45, v149, v25
    v_mfma_f32_16x16x32_bf16 v[104:107], a[76:79], a[60:63], v[104:107]
    v_mul_f32 v46, v153, v25
    v_mul_f32 v47, v157, v25
    v_mfma_f32_16x16x32_bf16 v[108:111], a[80:83], a[48:51], 0
    v_mul_f32 v48, v130, v26
    v_mul_f32 v49, v134, v26
    v_mfma_f32_16x16x32_bf16 v[108:111], a[84:87], a[52:55], v[108:111]
    v_mul_f32 v50, v138, v26
    v_mul_f32 v51, v142, v26
    v_mfma_f32_16x16x32_bf16 v[108:111], a[88:91], a[56:59], v[108:111]
    v_mul_f32 v52, v146, v26
    v_mul_f32 v53, v150, v26
    v_mfma_f32_16x16x32_bf16 v[108:111], a[92:95], a[60:63], v[108:111]
    v_exp_f32 v104, v104
    v_mfma_f32_16x16x32_bf16 v[224:227], v[76:79], a[128:131], v[224:227]
    v_exp_f32 v105, v105
    v_mfma_f32_16x16x32_bf16 v[228:231], v[76:79], a[132:135], v[228:231]
    v_exp_f32 v106, v106
    v_mfma_f32_16x16x32_bf16 v[232:235], v[76:79], a[136:139], v[232:235]
    v_exp_f32 v107, v107
    v_mfma_f32_16x16x32_bf16 v[236:239], v[76:79], a[140:143], v[236:239]
    v_exp_f32 v108, v108
    v_mfma_f32_16x16x32_bf16 v[240:243], v[76:79], a[144:147], v[240:243]
    v_exp_f32 v109, v109
    v_mfma_f32_16x16x32_bf16 v[244:247], v[76:79], a[148:151], v[244:247]
    v_exp_f32 v110, v110
    v_mfma_f32_16x16x32_bf16 v[248:251], v[76:79], a[152:155], v[248:251]
    v_exp_f32 v111, v111
    v_mfma_f32_16x16x32_bf16 v[252:255], v[76:79], a[156:159], v[252:255]
    v_mul_f32 v54, v154, v26
    v_mul_f32 v55, v158, v26
    v_mfma_f32_16x16x32_bf16 v[124:127], v[76:79], a[192:195], v[124:127]
    s_waitcnt lgkmcnt(8)
    v_cvt_pk_bf16_f32 v76, v104, v105
    v_cvt_pk_bf16_f32 v77, v106, v107
    v_mfma_f32_16x16x32_bf16 v[88:91], a[96:99], a[16:19], 0
    v_cvt_pk_bf16_f32 v78, v108, v109
    v_cvt_pk_bf16_f32 v79, v110, v111
    v_mfma_f32_16x16x32_bf16 v[88:91], a[100:103], a[20:23], v[88:91]
    v_mul_f32 v56, v131, v27
    v_mul_f32 v57, v135, v27
    v_mfma_f32_16x16x32_bf16 v[88:91], a[104:107], a[24:27], v[88:91]
    v_mul_f32 v58, v139, v27
    v_mul_f32 v59, v143, v27
    v_mfma_f32_16x16x32_bf16 v[88:91], a[108:111], a[28:31], v[88:91]
    v_mul_f32 v60, v147, v27
    v_mul_f32 v61, v151, v27
    v_mfma_f32_16x16x32_bf16 v[92:95], a[112:115], a[16:19], 0
    v_mul_f32 v62, v155, v27
    v_mul_f32 v63, v159, v27
    v_mfma_f32_16x16x32_bf16 v[92:95], a[116:119], a[20:23], v[92:95]
    ds_read_b128 a[64:67], v1 offset:16384
    ds_read_b128 a[68:71], v1 offset:16896
    v_mfma_f32_16x16x32_bf16 v[92:95], a[120:123], a[24:27], v[92:95]
    v_cvt_pk_bf16_f32 v32, v32, v33
    v_cvt_pk_bf16_f32 v33, v34, v35
    v_mfma_f32_16x16x32_bf16 v[92:95], a[124:127], a[28:31], v[92:95]
    s_waitcnt lgkmcnt(2)
    v_exp_f32 v88, v88
    v_mfma_f32_16x16x32_bf16 v[160:163], v[68:71], a[160:163], v[160:163]
    v_exp_f32 v89, v89
    v_mfma_f32_16x16x32_bf16 v[164:167], v[68:71], a[164:167], v[164:167]
    v_exp_f32 v90, v90
    v_mfma_f32_16x16x32_bf16 v[168:171], v[68:71], a[168:171], v[168:171]
    v_exp_f32 v91, v91
    v_mfma_f32_16x16x32_bf16 v[172:175], v[68:71], a[172:175], v[172:175]
    v_exp_f32 v92, v92
    v_mfma_f32_16x16x32_bf16 v[176:179], v[68:71], a[176:179], v[176:179]
    v_exp_f32 v93, v93
    v_mfma_f32_16x16x32_bf16 v[180:183], v[68:71], a[180:183], v[180:183]
    v_exp_f32 v94, v94
    v_mfma_f32_16x16x32_bf16 v[184:187], v[68:71], a[184:187], v[184:187]
    v_exp_f32 v95, v95
    v_mfma_f32_16x16x32_bf16 v[188:191], v[68:71], a[188:191], v[188:191]
    ds_read_b128 a[72:75], v1 offset:17408
    ds_read_b128 a[76:79], v1 offset:17920
    v_mfma_f32_16x16x32_bf16 v[116:119], v[68:71], a[192:195], v[116:119]
    v_cvt_pk_bf16_f32 v68, v88, v89
    v_cvt_pk_bf16_f32 v69, v90, v91
    v_mfma_f32_16x16x32_bf16 v[96:99], a[96:99], a[32:35], 0
    v_cvt_pk_bf16_f32 v70, v92, v93
    v_cvt_pk_bf16_f32 v71, v94, v95
    v_mfma_f32_16x16x32_bf16 v[96:99], a[100:103], a[36:39], v[96:99]
    ds_read_b128 a[80:83], v1 offset:20480
    ds_read_b128 a[84:87], v1 offset:20992
    v_mfma_f32_16x16x32_bf16 v[96:99], a[104:107], a[40:43], v[96:99]
    v_cvt_pk_bf16_f32 v34, v36, v37
    v_cvt_pk_bf16_f32 v35, v38, v39
    v_mfma_f32_16x16x32_bf16 v[96:99], a[108:111], a[44:47], v[96:99]
    ds_read_b128 a[88:91], v1 offset:21504
    ds_read_b128 a[92:95], v1 offset:22016
    v_mfma_f32_16x16x32_bf16 v[100:103], a[112:115], a[32:35], 0
    v_cvt_pk_bf16_f32 v40, v40, v41
    v_cvt_pk_bf16_f32 v41, v42, v43
    v_mfma_f32_16x16x32_bf16 v[100:103], a[116:119], a[36:39], v[100:103]
    ds_read_b128 a[128:131], v2 offset:8192
    ds_read_b128 a[132:135], v2 offset:9216
    v_mfma_f32_16x16x32_bf16 v[100:103], a[120:123], a[40:43], v[100:103]
    v_cvt_pk_bf16_f32 v42, v44, v45
    v_cvt_pk_bf16_f32 v43, v46, v47
    v_mfma_f32_16x16x32_bf16 v[100:103], a[124:127], a[44:47], v[100:103]
    v_exp_f32 v96, v96
    v_mfma_f32_16x16x32_bf16 v[192:195], v[72:75], a[160:163], v[192:195]
    v_exp_f32 v97, v97
    v_mfma_f32_16x16x32_bf16 v[196:199], v[72:75], a[164:167], v[196:199]
    v_exp_f32 v98, v98
    v_mfma_f32_16x16x32_bf16 v[200:203], v[72:75], a[168:171], v[200:203]
    v_exp_f32 v99, v99
    v_mfma_f32_16x16x32_bf16 v[204:207], v[72:75], a[172:175], v[204:207]
    v_exp_f32 v100, v100
    v_mfma_f32_16x16x32_bf16 v[208:211], v[72:75], a[176:179], v[208:211]
    v_exp_f32 v101, v101
    v_mfma_f32_16x16x32_bf16 v[212:215], v[72:75], a[180:183], v[212:215]
    v_exp_f32 v102, v102
    v_mfma_f32_16x16x32_bf16 v[216:219], v[72:75], a[184:187], v[216:219]
    v_exp_f32 v103, v103
    v_mfma_f32_16x16x32_bf16 v[220:223], v[72:75], a[188:191], v[220:223]
    ds_read_b128 a[136:139], v2 offset:10240
    ds_read_b128 a[140:143], v2 offset:11264
    v_mfma_f32_16x16x32_bf16 v[120:123], v[72:75], a[192:195], v[120:123]
    v_cvt_pk_bf16_f32 v72, v96, v97
    v_cvt_pk_bf16_f32 v73, v98, v99
    v_mfma_f32_16x16x32_bf16 v[104:107], a[96:99], a[48:51], 0
    ds_read_b128 a[144:147], v2 offset:12288
    ds_read_b128 a[148:151], v2 offset:13312
    v_mfma_f32_16x16x32_bf16 v[104:107], a[100:103], a[52:55], v[104:107]
    v_cvt_pk_bf16_f32 v74, v100, v101
    v_cvt_pk_bf16_f32 v75, v102, v103
    v_mfma_f32_16x16x32_bf16 v[104:107], a[104:107], a[56:59], v[104:107]
    ds_read_b128 a[152:155], v2 offset:14336
    ds_read_b128 a[156:159], v2 offset:15360
    v_mfma_f32_16x16x32_bf16 v[104:107], a[108:111], a[60:63], v[104:107]
    buffer_store_dwordx4 v[32:35], v5, s[24:27], s30 offen offset:0 sc1
    v_mfma_f32_16x16x32_bf16 v[108:111], a[112:115], a[48:51], 0
    v_cvt_pk_bf16_f32 v48, v48, v49
    v_cvt_pk_bf16_f32 v49, v50, v51
    v_mfma_f32_16x16x32_bf16 v[108:111], a[116:119], a[52:55], v[108:111]
    v_cvt_pk_bf16_f32 v50, v52, v53
    v_cvt_pk_bf16_f32 v51, v54, v55
    v_mfma_f32_16x16x32_bf16 v[108:111], a[120:123], a[56:59], v[108:111]
    buffer_store_dwordx4 v[40:43], v5, s[24:27], s30 offen offset:256 sc1
    v_mfma_f32_16x16x32_bf16 v[108:111], a[124:127], a[60:63], v[108:111]
    v_exp_f32 v104, v104
    v_mfma_f32_16x16x32_bf16 v[224:227], v[76:79], a[160:163], v[224:227]
    v_exp_f32 v105, v105
    v_mfma_f32_16x16x32_bf16 v[228:231], v[76:79], a[164:167], v[228:231]
    v_exp_f32 v106, v106
    v_mfma_f32_16x16x32_bf16 v[232:235], v[76:79], a[168:171], v[232:235]
    v_exp_f32 v107, v107
    v_mfma_f32_16x16x32_bf16 v[236:239], v[76:79], a[172:175], v[236:239]
    v_exp_f32 v108, v108
    v_mfma_f32_16x16x32_bf16 v[240:243], v[76:79], a[176:179], v[240:243]
    v_exp_f32 v109, v109
    v_mfma_f32_16x16x32_bf16 v[244:247], v[76:79], a[180:183], v[244:247]
    v_exp_f32 v110, v110
    v_mfma_f32_16x16x32_bf16 v[248:251], v[76:79], a[184:187], v[248:251]
    v_exp_f32 v111, v111
    v_mfma_f32_16x16x32_bf16 v[252:255], v[76:79], a[188:191], v[252:255]
    v_cvt_pk_bf16_f32 v56, v56, v57
    v_cvt_pk_bf16_f32 v57, v58, v59
    v_mfma_f32_16x16x32_bf16 v[124:127], v[76:79], a[192:195], v[124:127]
    s_waitcnt lgkmcnt(0)
    v_cvt_pk_bf16_f32 v58, v60, v61
    v_cvt_pk_bf16_f32 v59, v62, v63
    v_mfma_f32_16x16x32_bf16 v[160:163], v[68:71], a[128:131], v[160:163]
    buffer_store_dwordx4 v[48:51], v5, s[24:27], s30 offen offset:512 sc1
    v_mfma_f32_16x16x32_bf16 v[164:167], v[68:71], a[132:135], v[164:167]
    v_max3_f32 v28, v28, v24, v25
    v_min3_f32 v29, v29, v24, v25
    v_mfma_f32_16x16x32_bf16 v[168:171], v[68:71], a[136:139], v[168:171]
    v_max3_f32 v28, v28, v26, v27
    v_min3_f32 v29, v29, v26, v27
    v_mfma_f32_16x16x32_bf16 v[172:175], v[68:71], a[140:143], v[172:175]
    buffer_store_dwordx4 v[56:59], v5, s[24:27], s30 offen offset:768 sc1
    v_mfma_f32_16x16x32_bf16 v[176:179], v[68:71], a[144:147], v[176:179]
    s_add_u32 s30, s30, 0x4000
    v_cvt_pk_bf16_f32 v76, v104, v105
    v_cvt_pk_bf16_f32 v77, v106, v107
    v_mfma_f32_16x16x32_bf16 v[180:183], v[68:71], a[148:151], v[180:183]
    v_cvt_pk_bf16_f32 v78, v108, v109
    v_cvt_pk_bf16_f32 v79, v110, v111
    v_mfma_f32_16x16x32_bf16 v[184:187], v[68:71], a[152:155], v[184:187]
    ds_read_b128 a[96:99], v1 offset:24576
    ds_read_b128 a[100:103], v1 offset:25088
    v_mfma_f32_16x16x32_bf16 v[188:191], v[68:71], a[156:159], v[188:191]
    v_mfma_f32_16x16x32_bf16 v[116:119], v[68:71], a[192:195], v[116:119]
    ds_read_b128 a[104:107], v1 offset:25600
    ds_read_b128 a[108:111], v1 offset:26112
    v_mfma_f32_16x16x32_bf16 v[96:99], a[64:67], a[32:35], 0
    v_mfma_f32_16x16x32_bf16 v[96:99], a[68:71], a[36:39], v[96:99]
    ds_read_b128 a[112:115], v1 offset:28672
    ds_read_b128 a[116:119], v1 offset:29184
    v_mfma_f32_16x16x32_bf16 v[96:99], a[72:75], a[40:43], v[96:99]
    v_mfma_f32_16x16x32_bf16 v[96:99], a[76:79], a[44:47], v[96:99]
    ds_read_b128 a[120:123], v1 offset:29696
    ds_read_b128 a[124:127], v1 offset:30208
    v_mfma_f32_16x16x32_bf16 v[100:103], a[80:83], a[32:35], 0
    v_rcp_f32 v24, v116
    v_mfma_f32_16x16x32_bf16 v[100:103], a[84:87], a[36:39], v[100:103]
    ds_read_b128 a[160:163], v2 offset:16384
    ds_read_b128 a[164:167], v2 offset:17408
    v_mfma_f32_16x16x32_bf16 v[100:103], a[88:91], a[40:43], v[100:103]
    v_rcp_f32 v25, v117
    v_mfma_f32_16x16x32_bf16 v[100:103], a[92:95], a[44:47], v[100:103]
    v_exp_f32 v96, v96
    v_mfma_f32_16x16x32_bf16 v[192:195], v[72:75], a[128:131], v[192:195]
    v_exp_f32 v97, v97
    v_mfma_f32_16x16x32_bf16 v[196:199], v[72:75], a[132:135], v[196:199]
    v_exp_f32 v98, v98
    v_mfma_f32_16x16x32_bf16 v[200:203], v[72:75], a[136:139], v[200:203]
    v_exp_f32 v99, v99
    v_mfma_f32_16x16x32_bf16 v[204:207], v[72:75], a[140:143], v[204:207]
    v_exp_f32 v100, v100
    v_mfma_f32_16x16x32_bf16 v[208:211], v[72:75], a[144:147], v[208:211]
    v_exp_f32 v101, v101
    v_mfma_f32_16x16x32_bf16 v[212:215], v[72:75], a[148:151], v[212:215]
    v_exp_f32 v102, v102
    v_mfma_f32_16x16x32_bf16 v[216:219], v[72:75], a[152:155], v[216:219]
    v_exp_f32 v103, v103
    v_mfma_f32_16x16x32_bf16 v[220:223], v[72:75], a[156:159], v[220:223]
    ds_read_b128 a[168:171], v2 offset:18432
    ds_read_b128 a[172:175], v2 offset:19456
    v_mfma_f32_16x16x32_bf16 v[120:123], v[72:75], a[192:195], v[120:123]
    v_cvt_pk_bf16_f32 v72, v96, v97
    v_cvt_pk_bf16_f32 v73, v98, v99
    v_mfma_f32_16x16x32_bf16 v[104:107], a[64:67], a[48:51], 0
    ds_read_b128 a[176:179], v2 offset:20480
    ds_read_b128 a[180:183], v2 offset:21504
    v_mfma_f32_16x16x32_bf16 v[104:107], a[68:71], a[52:55], v[104:107]
    v_cvt_pk_bf16_f32 v74, v100, v101
    v_cvt_pk_bf16_f32 v75, v102, v103
    v_mfma_f32_16x16x32_bf16 v[104:107], a[72:75], a[56:59], v[104:107]
    ds_read_b128 a[184:187], v2 offset:22528
    ds_read_b128 a[188:191], v2 offset:23552
    v_mfma_f32_16x16x32_bf16 v[104:107], a[76:79], a[60:63], v[104:107]
    v_rcp_f32 v26, v118
    v_mfma_f32_16x16x32_bf16 v[108:111], a[80:83], a[48:51], 0
    v_rcp_f32 v27, v119
    v_mfma_f32_16x16x32_bf16 v[108:111], a[84:87], a[52:55], v[108:111]
    v_mul_f32 v32, v160, v24
    v_mul_f32 v33, v164, v24
    v_mul_f32 v34, v168, v24
    v_mfma_f32_16x16x32_bf16 v[108:111], a[88:91], a[56:59], v[108:111]
    v_mul_f32 v35, v172, v24
    v_mul_f32 v36, v176, v24
    v_mul_f32 v37, v180, v24
    v_mfma_f32_16x16x32_bf16 v[108:111], a[92:95], a[60:63], v[108:111]
    v_exp_f32 v104, v104
    v_mul_f32 v38, v184, v24
    v_mfma_f32_16x16x32_bf16 v[224:227], v[76:79], a[128:131], v[224:227]
    v_exp_f32 v105, v105
    v_mfma_f32_16x16x32_bf16 v[228:231], v[76:79], a[132:135], v[228:231]
    v_exp_f32 v106, v106
    v_mfma_f32_16x16x32_bf16 v[232:235], v[76:79], a[136:139], v[232:235]
    v_exp_f32 v107, v107
    v_mfma_f32_16x16x32_bf16 v[236:239], v[76:79], a[140:143], v[236:239]
    v_exp_f32 v108, v108
    v_mfma_f32_16x16x32_bf16 v[240:243], v[76:79], a[144:147], v[240:243]
    v_exp_f32 v109, v109
    v_mfma_f32_16x16x32_bf16 v[244:247], v[76:79], a[148:151], v[244:247]
    v_exp_f32 v110, v110
    v_mfma_f32_16x16x32_bf16 v[248:251], v[76:79], a[152:155], v[248:251]
    v_exp_f32 v111, v111
    v_mfma_f32_16x16x32_bf16 v[252:255], v[76:79], a[156:159], v[252:255]
    v_mul_f32 v39, v188, v24
    v_mul_f32 v40, v161, v25
    v_mfma_f32_16x16x32_bf16 v[124:127], v[76:79], a[192:195], v[124:127]
    s_waitcnt lgkmcnt(8)
    v_cvt_pk_bf16_f32 v76, v104, v105
    v_cvt_pk_bf16_f32 v77, v106, v107
    v_mfma_f32_16x16x32_bf16 v[96:99], a[96:99], a[32:35], 0
    v_cvt_pk_bf16_f32 v78, v108, v109
    v_cvt_pk_bf16_f32 v79, v110, v111
    v_mfma_f32_16x16x32_bf16 v[96:99], a[100:103], a[36:39], v[96:99]
    v_mul_f32 v41, v165, v25
    v_mul_f32 v42, v169, v25
    v_mfma_f32_16x16x32_bf16 v[96:99], a[104:107], a[40:43], v[96:99]
    v_mul_f32 v43, v173, v25
    v_mul_f32 v44, v177, v25
    v_mul_f32 v45, v181, v25
    v_mfma_f32_16x16x32_bf16 v[96:99], a[108:111], a[44:47], v[96:99]
    v_mul_f32 v46, v185, v25
    v_mul_f32 v47, v189, v25
    v_mul_f32 v48, v162, v26
    v_mfma_f32_16x16x32_bf16 v[100:103], a[112:115], a[32:35], 0
    v_mul_f32 v49, v166, v26
    v_mul_f32 v50, v170, v26
    v_mul_f32 v51, v174, v26
    v_mfma_f32_16x16x32_bf16 v[100:103], a[116:119], a[36:39], v[100:103]
    v_mul_f32 v52, v178, v26
    v_mul_f32 v53, v182, v26
    v_mul_f32 v54, v186, v26
    v_mfma_f32_16x16x32_bf16 v[100:103], a[120:123], a[40:43], v[100:103]
    v_mul_f32 v55, v190, v26
    v_mul_f32 v56, v163, v27
    v_mul_f32 v57, v167, v27
    v_mfma_f32_16x16x32_bf16 v[100:103], a[124:127], a[44:47], v[100:103]
    s_waitcnt lgkmcnt(0)
    v_mul_f32 v58, v171, v27
    v_mul_f32 v59, v175, v27
    v_mul_f32 v60, v179, v27
    v_mfma_f32_16x16x32_bf16 v[192:195], v[72:75], a[160:163], v[192:195]
    v_mul_f32 v61, v183, v27
    v_mul_f32 v62, v187, v27
    v_mul_f32 v63, v191, v27
    v_mfma_f32_16x16x32_bf16 v[196:199], v[72:75], a[164:167], v[196:199]
    ds_read_b128 a[64:67], v1 offset:32768
    v_exp_f32 v96, v96
    v_mfma_f32_16x16x32_bf16 v[200:203], v[72:75], a[168:171], v[200:203]
    v_exp_f32 v97, v97
    v_cvt_pk_bf16_f32 v32, v32, v33
    v_mfma_f32_16x16x32_bf16 v[204:207], v[72:75], a[172:175], v[204:207]
    ds_read_b128 a[68:71], v1 offset:33280
    v_exp_f32 v98, v98
    v_mfma_f32_16x16x32_bf16 v[208:211], v[72:75], a[176:179], v[208:211]
    v_exp_f32 v99, v99
    v_cvt_pk_bf16_f32 v33, v34, v35
    v_mfma_f32_16x16x32_bf16 v[212:215], v[72:75], a[180:183], v[212:215]
    ds_read_b128 a[72:75], v1 offset:33792
    v_exp_f32 v100, v100
    v_mfma_f32_16x16x32_bf16 v[216:219], v[72:75], a[184:187], v[216:219]
    v_exp_f32 v101, v101
    v_cvt_pk_bf16_f32 v34, v36, v37
    v_mfma_f32_16x16x32_bf16 v[220:223], v[72:75], a[188:191], v[220:223]
    ds_read_b128 a[76:79], v1 offset:34304
    v_exp_f32 v102, v102
    v_mfma_f32_16x16x32_bf16 v[120:123], v[72:75], a[192:195], v[120:123]
    v_exp_f32 v103, v103
    v_cvt_pk_bf16_f32 v72, v96, v97
    v_mfma_f32_16x16x32_bf16 v[104:107], a[96:99], a[48:51], 0
    ds_read_b128 a[80:83], v1 offset:36864
    ds_read_b128 a[84:87], v1 offset:37376
    v_cvt_pk_bf16_f32 v73, v98, v99
    v_mfma_f32_16x16x32_bf16 v[104:107], a[100:103], a[52:55], v[104:107]
    v_cvt_pk_bf16_f32 v74, v100, v101
    v_cvt_pk_bf16_f32 v75, v102, v103
    v_cvt_pk_bf16_f32 v35, v38, v39
    v_mfma_f32_16x16x32_bf16 v[104:107], a[104:107], a[56:59], v[104:107]
    ds_read_b128 a[88:91], v1 offset:37888
    ds_read_b128 a[92:95], v1 offset:38400
    v_cvt_pk_bf16_f32 v40, v40, v41
    v_mfma_f32_16x16x32_bf16 v[104:107], a[108:111], a[60:63], v[104:107]
    v_cvt_pk_bf16_f32 v41, v42, v43
    v_cvt_pk_bf16_f32 v42, v44, v45
    v_cvt_pk_bf16_f32 v43, v46, v47
    v_mfma_f32_16x16x32_bf16 v[108:111], a[112:115], a[48:51], 0
    ds_read_b128 a[128:131], v2 offset:24576
    ds_read_b128 a[132:135], v2 offset:25600
    v_mfma_f32_16x16x32_bf16 v[108:111], a[116:119], a[52:55], v[108:111]
    buffer_store_dwordx4 v[32:35], v5, s[24:27], s30 offen offset:0 sc1
    v_cvt_pk_bf16_f32 v48, v48, v49
    v_mfma_f32_16x16x32_bf16 v[108:111], a[120:123], a[56:59], v[108:111]
    ds_read_b128 a[136:139], v2 offset:26624
    ds_read_b128 a[140:143], v2 offset:27648
    v_cvt_pk_bf16_f32 v49, v50, v51
    v_mfma_f32_16x16x32_bf16 v[108:111], a[124:127], a[60:63], v[108:111]
    v_exp_f32 v104, v104
    v_cvt_pk_bf16_f32 v50, v52, v53
    v_mfma_f32_16x16x32_bf16 v[224:227], v[76:79], a[160:163], v[224:227]
    ds_read_b128 a[144:147], v2 offset:28672
    ds_read_b128 a[148:151], v2 offset:29696
    v_cvt_pk_bf16_f32 v51, v54, v55
    v_mfma_f32_16x16x32_bf16 v[228:231], v[76:79], a[164:167], v[228:231]
    v_exp_f32 v105, v105
    v_mfma_f32_16x16x32_bf16 v[232:235], v[76:79], a[168:171], v[232:235]
    ds_read_b128 a[152:155], v2 offset:30720
    ds_read_b128 a[156:159], v2 offset:31744
    v_mfma_f32_16x16x32_bf16 v[236:239], v[76:79], a[172:175], v[236:239]
    v_exp_f32 v106, v106
    v_mfma_f32_16x16x32_bf16 v[240:243], v[76:79], a[176:179], v[240:243]
    v_exp_f32 v107, v107
    v_mfma_f32_16x16x32_bf16 v[244:247], v[76:79], a[180:183], v[244:247]
    v_exp_f32 v108, v108
    v_mfma_f32_16x16x32_bf16 v[248:251], v[76:79], a[184:187], v[248:251]
    v_exp_f32 v109, v109
    v_mfma_f32_16x16x32_bf16 v[252:255], v[76:79], a[188:191], v[252:255]
    v_exp_f32 v110, v110
    v_mfma_f32_16x16x32_bf16 v[124:127], v[76:79], a[192:195], v[124:127]
    s_waitcnt lgkmcnt(0)
    v_exp_f32 v111, v111
    v_cvt_pk_bf16_f32 v76, v104, v105
    v_mfma_f32_16x16x32_bf16 v[192:195], v[72:75], a[128:131], v[192:195]
    v_cvt_pk_bf16_f32 v77, v106, v107
    v_cvt_pk_bf16_f32 v78, v108, v109
    v_cvt_pk_bf16_f32 v79, v110, v111
    v_mfma_f32_16x16x32_bf16 v[196:199], v[72:75], a[132:135], v[196:199]
    buffer_store_dwordx4 v[40:43], v5, s[24:27], s30 offen offset:256 sc1
    v_cvt_pk_bf16_f32 v56, v56, v57
    v_mfma_f32_16x16x32_bf16 v[200:203], v[72:75], a[136:139], v[200:203]
    v_cvt_pk_bf16_f32 v57, v58, v59
    v_cvt_pk_bf16_f32 v58, v60, v61
    v_cvt_pk_bf16_f32 v59, v62, v63
    v_mfma_f32_16x16x32_bf16 v[204:207], v[72:75], a[140:143], v[204:207]
    buffer_store_dwordx4 v[48:51], v5, s[24:27], s30 offen offset:512 sc1
    v_max3_f32 v28, v28, v24, v25
    v_mfma_f32_16x16x32_bf16 v[208:211], v[72:75], a[144:147], v[208:211]
    v_min3_f32 v29, v29, v24, v25
    v_max3_f32 v28, v28, v26, v27
    v_min3_f32 v29, v29, v26, v27
    v_mfma_f32_16x16x32_bf16 v[212:215], v[72:75], a[148:151], v[212:215]
    buffer_store_dwordx4 v[56:59], v5, s[24:27], s30 offen offset:768 sc1
    ds_read_b128 a[96:99], v1 offset:40960
    v_mfma_f32_16x16x32_bf16 v[216:219], v[72:75], a[152:155], v[216:219]
    s_add_u32 s30, s30, 0x4000
    v_mfma_f32_16x16x32_bf16 v[220:223], v[72:75], a[156:159], v[220:223]
    ds_read_b128 a[100:103], v1 offset:41472
    ds_read_b128 a[104:107], v1 offset:41984
    v_mfma_f32_16x16x32_bf16 v[120:123], v[72:75], a[192:195], v[120:123]
    v_mfma_f32_16x16x32_bf16 v[104:107], a[64:67], a[48:51], 0
    ds_read_b128 a[108:111], v1 offset:42496
    ds_read_b128 a[112:115], v1 offset:45056
    v_mfma_f32_16x16x32_bf16 v[104:107], a[68:71], a[52:55], v[104:107]
    v_mfma_f32_16x16x32_bf16 v[104:107], a[72:75], a[56:59], v[104:107]
    ds_read_b128 a[116:119], v1 offset:45568
    ds_read_b128 a[120:123], v1 offset:46080
    v_mfma_f32_16x16x32_bf16 v[104:107], a[76:79], a[60:63], v[104:107]
    v_rcp_f32 v24, v120
    v_mfma_f32_16x16x32_bf16 v[108:111], a[80:83], a[48:51], 0
    ds_read_b128 a[124:127], v1 offset:46592
    ds_read_b128 a[160:163], v2 offset:32768
    v_mfma_f32_16x16x32_bf16 v[108:111], a[84:87], a[52:55], v[108:111]
    v_rcp_f32 v25, v121
    v_mfma_f32_16x16x32_bf16 v[108:111], a[88:91], a[56:59], v[108:111]
    ds_read_b128 a[164:167], v2 offset:33792
    ds_read_b128 a[168:171], v2 offset:34816
    v_mfma_f32_16x16x32_bf16 v[108:111], a[92:95], a[60:63], v[108:111]
    v_exp_f32 v104, v104
    v_mfma_f32_16x16x32_bf16 v[224:227], v[76:79], a[128:131], v[224:227]
    ds_read_b128 a[172:175], v2 offset:35840
    ds_read_b128 a[176:179], v2 offset:36864
    v_mfma_f32_16x16x32_bf16 v[228:231], v[76:79], a[132:135], v[228:231]
    v_exp_f32 v105, v105
    v_mfma_f32_16x16x32_bf16 v[232:235], v[76:79], a[136:139], v[232:235]
    ds_read_b128 a[180:183], v2 offset:37888
    ds_read_b128 a[184:187], v2 offset:38912
    v_mfma_f32_16x16x32_bf16 v[236:239], v[76:79], a[140:143], v[236:239]
    ds_read_b128 a[188:191], v2 offset:39936
    v_exp_f32 v106, v106
    v_mfma_f32_16x16x32_bf16 v[240:243], v[76:79], a[144:147], v[240:243]
    v_exp_f32 v107, v107
    v_mfma_f32_16x16x32_bf16 v[244:247], v[76:79], a[148:151], v[244:247]
    v_exp_f32 v108, v108
    v_mfma_f32_16x16x32_bf16 v[248:251], v[76:79], a[152:155], v[248:251]
    v_exp_f32 v109, v109
    v_mfma_f32_16x16x32_bf16 v[252:255], v[76:79], a[156:159], v[252:255]
    v_exp_f32 v110, v110
    v_mfma_f32_16x16x32_bf16 v[124:127], v[76:79], a[192:195], v[124:127]
    s_waitcnt lgkmcnt(8)
    v_exp_f32 v111, v111
    v_cvt_pk_bf16_f32 v76, v104, v105
    v_cvt_pk_bf16_f32 v77, v106, v107
    v_cvt_pk_bf16_f32 v78, v108, v109
    v_cvt_pk_bf16_f32 v79, v110, v111
    v_mfma_f32_16x16x32_bf16 v[104:107], a[96:99], a[48:51], 0
    ds_read_b128 a[128:131], v2 offset:40960
    v_rcp_f32 v26, v122
    v_mfma_f32_16x16x32_bf16 v[104:107], a[100:103], a[52:55], v[104:107]
    v_rcp_f32 v27, v123
    v_mul_f32 v32, v192, v24
    v_mul_f32 v33, v196, v24
    v_mul_f32 v34, v200, v24
    v_mul_f32 v35, v204, v24
    v_mul_f32 v36, v208, v24
    v_mul_f32 v37, v212, v24
    v_mul_f32 v38, v216, v24
    v_mul_f32 v39, v220, v24
    v_mul_f32 v40, v193, v25
    v_mul_f32 v41, v197, v25
    v_mul_f32 v42, v201, v25
    v_mul_f32 v43, v205, v25
    v_mul_f32 v44, v209, v25
    v_mul_f32 v45, v213, v25
    v_mul_f32 v46, v217, v25
    v_mul_f32 v47, v221, v25
    v_mul_f32 v48, v194, v26
    v_mul_f32 v49, v198, v26
    v_mul_f32 v50, v202, v26
    v_mul_f32 v51, v206, v26
    v_mul_f32 v52, v210, v26
    v_mul_f32 v53, v214, v26
    v_mul_f32 v54, v218, v26
    v_mul_f32 v55, v222, v26
    v_mul_f32 v56, v195, v27
    v_mul_f32 v57, v199, v27
    v_mul_f32 v58, v203, v27
    v_mul_f32 v59, v207, v27
    v_mul_f32 v60, v211, v27
    v_mul_f32 v61, v215, v27
    v_mul_f32 v62, v219, v27
    v_mul_f32 v63, v223, v27
    v_mfma_f32_16x16x32_bf16 v[104:107], a[104:107], a[56:59], v[104:107]
    ds_read_b128 a[132:135], v2 offset:41984
    ds_read_b128 a[136:139], v2 offset:43008
    v_cvt_pk_bf16_f32 v32, v32, v33
    v_mfma_f32_16x16x32_bf16 v[104:107], a[108:111], a[60:63], v[104:107]
    v_cvt_pk_bf16_f32 v33, v34, v35
    v_cvt_pk_bf16_f32 v34, v36, v37
    v_cvt_pk_bf16_f32 v35, v38, v39
    v_mfma_f32_16x16x32_bf16 v[108:111], a[112:115], a[48:51], 0
    ds_read_b128 a[140:143], v2 offset:44032
    ds_read_b128 a[144:147], v2 offset:45056
    v_cvt_pk_bf16_f32 v40, v40, v41
    v_mfma_f32_16x16x32_bf16 v[108:111], a[116:119], a[52:55], v[108:111]
    v_cvt_pk_bf16_f32 v41, v42, v43
    v_cvt_pk_bf16_f32 v42, v44, v45
    v_cvt_pk_bf16_f32 v43, v46, v47
    v_mfma_f32_16x16x32_bf16 v[108:111], a[120:123], a[56:59], v[108:111]
    ds_read_b128 a[148:151], v2 offset:46080
    ds_read_b128 a[152:155], v2 offset:47104
    v_mfma_f32_16x16x32_bf16 v[108:111], a[124:127], a[60:63], v[108:111]
    s_waitcnt lgkmcnt(7)
    v_exp_f32 v104, v104
    v_mfma_f32_16x16x32_bf16 v[224:227], v[76:79], a[160:163], v[224:227]
    ds_read_b128 a[156:159], v2 offset:48128
    v_exp_f32 v105, v105
    v_mfma_f32_16x16x32_bf16 v[228:231], v[76:79], a[164:167], v[228:231]
    v_exp_f32 v106, v106
    v_mfma_f32_16x16x32_bf16 v[232:235], v[76:79], a[168:171], v[232:235]
    v_exp_f32 v107, v107
    v_mfma_f32_16x16x32_bf16 v[236:239], v[76:79], a[172:175], v[236:239]
    v_exp_f32 v108, v108
    v_mfma_f32_16x16x32_bf16 v[240:243], v[76:79], a[176:179], v[240:243]
    v_exp_f32 v109, v109
    v_mfma_f32_16x16x32_bf16 v[244:247], v[76:79], a[180:183], v[244:247]
    v_exp_f32 v110, v110
    v_mfma_f32_16x16x32_bf16 v[248:251], v[76:79], a[184:187], v[248:251]
    v_exp_f32 v111, v111
    v_mfma_f32_16x16x32_bf16 v[252:255], v[76:79], a[188:191], v[252:255]
    buffer_store_dwordx4 v[32:35], v5, s[24:27], s30 offen offset:0 sc1
    v_cvt_pk_bf16_f32 v48, v48, v49
    v_mfma_f32_16x16x32_bf16 v[124:127], v[76:79], a[192:195], v[124:127]
    s_waitcnt lgkmcnt(0)
    v_cvt_pk_bf16_f32 v76, v104, v105
    v_cvt_pk_bf16_f32 v77, v106, v107
    v_cvt_pk_bf16_f32 v78, v108, v109
    v_cvt_pk_bf16_f32 v79, v110, v111
    s_nop 1
    v_mfma_f32_16x16x32_bf16 v[224:227], v[76:79], a[128:131], v[224:227]
    v_cvt_pk_bf16_f32 v49, v50, v51
    v_cvt_pk_bf16_f32 v50, v52, v53
    v_mfma_f32_16x16x32_bf16 v[228:231], v[76:79], a[132:135], v[228:231]
    v_cvt_pk_bf16_f32 v51, v54, v55
    v_mfma_f32_16x16x32_bf16 v[232:235], v[76:79], a[136:139], v[232:235]
    buffer_store_dwordx4 v[40:43], v5, s[24:27], s30 offen offset:256 sc1
    v_cvt_pk_bf16_f32 v56, v56, v57
    v_mfma_f32_16x16x32_bf16 v[236:239], v[76:79], a[140:143], v[236:239]
    v_cvt_pk_bf16_f32 v57, v58, v59
    v_cvt_pk_bf16_f32 v58, v60, v61
    v_mfma_f32_16x16x32_bf16 v[240:243], v[76:79], a[144:147], v[240:243]
    v_cvt_pk_bf16_f32 v59, v62, v63
    v_mfma_f32_16x16x32_bf16 v[244:247], v[76:79], a[148:151], v[244:247]
    buffer_store_dwordx4 v[48:51], v5, s[24:27], s30 offen offset:512 sc1
    v_max3_f32 v28, v28, v24, v25
    v_mfma_f32_16x16x32_bf16 v[248:251], v[76:79], a[152:155], v[248:251]
    v_min3_f32 v29, v29, v24, v25
    v_max3_f32 v28, v28, v26, v27
    v_mfma_f32_16x16x32_bf16 v[252:255], v[76:79], a[156:159], v[252:255]
    v_min3_f32 v29, v29, v26, v27
    v_mfma_f32_16x16x32_bf16 v[124:127], v[76:79], a[192:195], v[124:127]
    buffer_store_dwordx4 v[56:59], v5, s[24:27], s30 offen offset:768 sc1
    s_add_u32 s30, s30, 0x4000
    s_nop 5
    v_rcp_f32 v24, v124
    v_rcp_f32 v25, v125
    v_rcp_f32 v26, v126
    v_rcp_f32 v27, v127
    v_mul_f32 v32, v224, v24
    v_mul_f32 v33, v228, v24
    v_mul_f32 v34, v232, v24
    v_mul_f32 v35, v236, v24
    v_mul_f32 v36, v240, v24
    v_mul_f32 v37, v244, v24
    v_mul_f32 v38, v248, v24
    v_mul_f32 v39, v252, v24
    v_mul_f32 v40, v225, v25
    v_mul_f32 v41, v229, v25
    v_mul_f32 v42, v233, v25
    v_mul_f32 v43, v237, v25
    v_mul_f32 v44, v241, v25
    v_mul_f32 v45, v245, v25
    v_mul_f32 v46, v249, v25
    v_mul_f32 v47, v253, v25
    v_mul_f32 v48, v226, v26
    v_mul_f32 v49, v230, v26
    v_mul_f32 v50, v234, v26
    v_mul_f32 v51, v238, v26
    v_mul_f32 v52, v242, v26
    v_mul_f32 v53, v246, v26
    v_mul_f32 v54, v250, v26
    v_mul_f32 v55, v254, v26
    v_mul_f32 v56, v227, v27
    v_mul_f32 v57, v231, v27
    v_mul_f32 v58, v235, v27
    v_mul_f32 v59, v239, v27
    v_mul_f32 v60, v243, v27
    v_mul_f32 v61, v247, v27
    v_mul_f32 v62, v251, v27
    v_mul_f32 v63, v255, v27
    v_cvt_pk_bf16_f32 v32, v32, v33
    v_cvt_pk_bf16_f32 v33, v34, v35
    v_cvt_pk_bf16_f32 v34, v36, v37
    v_cvt_pk_bf16_f32 v35, v38, v39
    v_cvt_pk_bf16_f32 v40, v40, v41
    v_cvt_pk_bf16_f32 v41, v42, v43
    v_cvt_pk_bf16_f32 v42, v44, v45
    v_cvt_pk_bf16_f32 v43, v46, v47
    buffer_store_dwordx4 v[32:35], v5, s[24:27], s30 offen offset:0 sc1
    v_cvt_pk_bf16_f32 v48, v48, v49
    v_cvt_pk_bf16_f32 v49, v50, v51
    v_cvt_pk_bf16_f32 v50, v52, v53
    v_cvt_pk_bf16_f32 v51, v54, v55
    buffer_store_dwordx4 v[40:43], v5, s[24:27], s30 offen offset:256 sc1
    v_cvt_pk_bf16_f32 v56, v56, v57
    v_cvt_pk_bf16_f32 v57, v58, v59
    v_cvt_pk_bf16_f32 v58, v60, v61
    v_cvt_pk_bf16_f32 v59, v62, v63
    buffer_store_dwordx4 v[48:51], v5, s[24:27], s30 offen offset:512 sc1
    v_max3_f32 v28, v28, v24, v25
    v_min3_f32 v29, v29, v24, v25
    v_max3_f32 v28, v28, v26, v27
    v_min3_f32 v29, v29, v26, v27
    buffer_store_dwordx4 v[56:59], v5, s[24:27], s30 offen offset:768 sc1
    s_add_u32 s30, s30, 0x4000
    v_cmp_nge_f32_e64 s[44:45], s38, v28
    v_cmp_nle_f32_e64 s[46:47], s43, v29
    s_nop 0
    s_or_b64 s[44:45], s[44:45], s[46:47]
    s_cselect_b32 s33, 0xffff, 0
L_slow:
    s_cmp_eq_u32 s33, 0
    s_cbranch_scc1 L_done
    s_ff1_i32_b32 s32, s33
    s_bitset0_b32 s33, s32
    s_lshl_b32 s30, s32, 14
    s_add_u32 s30, s30, s36
    s_add_u32 s39, s30, 128
    s_waitcnt vmcnt(0)
    s_waitcnt lgkmcnt(0)
    s_add_u32 m0, s31, 0
    s_nop 0
    buffer_load_dwordx4 v4, s[12:15], s30 offen offset:0 nt lds
    buffer_load_dwordx4 v4, s[12:15], s30 offen offset:2048 nt lds
    s_add_u32 m0, s31, 1024
    s_nop 0
    buffer_load_dwordx4 v4, s[12:15], s39 offen offset:0 nt lds
    buffer_load_dwordx4 v4, s[12:15], s39 offen offset:2048 nt lds
    s_waitcnt vmcnt(0)
    ds_read_b128 a[0:3], v3 offset:0
    ds_read_b128 a[4:7], v3 offset:512
    ds_read_b128 a[8:11], v3 offset:1024
    ds_read_b128 a[12:15], v3 offset:1536
    v_mov_b32 v30, 0xff800000
    v_mov_b32 v28, v1
    s_mov_b32 s37, 8
    s_waitcnt lgkmcnt(0)
L_slow_max:
    ds_read_b128 a[64:67], v28 offset:0
    ds_read_b128 a[68:71], v28 offset:512
    ds_read_b128 a[72:75], v28 offset:1024
    ds_read_b128 a[76:79], v28 offset:1536
    ds_read_b128 a[80:83], v28 offset:4096
    ds_read_b128 a[84:87], v28 offset:4608
    ds_read_b128 a[88:91], v28 offset:5120
    ds_read_b128 a[92:95], v28 offset:5632
    s_waitcnt lgkmcnt(0)
    v_mfma_f32_16x16x32_bf16 v[80:83], a[64:67], a[0:3], 0
    v_mfma_f32_16x16x32_bf16 v[80:83], a[68:71], a[4:7], v[80:83]
    v_mfma_f32_16x16x32_bf16 v[80:83], a[72:75], a[8:11], v[80:83]
    v_mfma_f32_16x16x32_bf16 v[80:83], a[76:79], a[12:15], v[80:83]
    v_mfma_f32_16x16x32_bf16 v[84:87], a[80:83], a[0:3], 0
    v_mfma_f32_16x16x32_bf16 v[84:87], a[84:87], a[4:7], v[84:87]
    v_mfma_f32_16x16x32_bf16 v[84:87], a[88:91], a[8:11], v[84:87]
    v_mfma_f32_16x16x32_bf16 v[84:87], a[92:95], a[12:15], v[84:87]
    s_nop 15
    v_max3_f32 v30, v30, v80, v81
    v_max3_f32 v30, v30, v82, v83
    v_max3_f32 v30, v30, v84, v85
    v_max3_f32 v30, v30, v86, v87
    v_add_u32 v28, 0x2000, v28
    s_sub_u32 s37, s37, 1
    s_cmp_lg_u32 s37, 0
    s_cbranch_scc1 L_slow_max
    s_nop 1
    v_mov_b32 v31, v30
    s_nop 1
    v_permlane16_swap_b32 v30, v31
    v_max_f32 v30, v30, v31
    v_mov_b32 v31, v30
    s_nop 1
    v_permlane32_swap_b32 v30, v31
    v_max_f32 v30, v30, v31
    v_mov_b32 v128, 0
    v_mov_b32 v129, 0
    v_mov_b32 v130, 0
    v_mov_b32 v131, 0
    v_mov_b32 v132, 0
    v_mov_b32 v133, 0
    v_mov_b32 v134, 0
    v_mov_b32 v135, 0
    v_mov_b32 v136, 0
    v_mov_b32 v137, 0
    v_mov_b32 v138, 0
    v_mov_b32 v139, 0
    v_mov_b32 v140, 0
    v_mov_b32 v141, 0
    v_mov_b32 v142, 0
    v_mov_b32 v143, 0
    v_mov_b32 v144, 0
    v_mov_b32 v145, 0
    v_mov_b32 v146, 0
    v_mov_b32 v147, 0
    v_mov_b32 v148, 0
    v_mov_b32 v149, 0
    v_mov_b32 v150, 0
    v_mov_b32 v151, 0
    v_mov_b32 v152, 0
    v_mov_b32 v153, 0
    v_mov_b32 v154, 0
    v_mov_b32 v155, 0
    v_mov_b32 v156, 0
    v_mov_b32 v157, 0
    v_mov_b32 v158, 0
    v_mov_b32 v159, 0
    v_mov_b32 v112, 0
    v_mov_b32 v113, 0
    v_mov_b32 v114, 0
    v_mov_b32 v115, 0
    v_mov_b32 v28, v1
    v_mov_b32 v29, v2
    s_mov_b32 s37, 8
L_slow_pv:
    ds_read_b128 a[64:67], v28 offset:0
    ds_read_b128 a[68:71], v28 offset:512
    ds_read_b128 a[72:75], v28 offset:1024
    ds_read_b128 a[76:79], v28 offset:1536
    ds_read_b128 a[80:83], v28 offset:4096
    ds_read_b128 a[84:87], v28 offset:4608
    ds_read_b128 a[88:91], v28 offset:5120
    ds_read_b128 a[92:95], v28 offset:5632
    ds_read_b128 a[128:131], v29 offset:0
    ds_read_b128 a[132:135], v29 offset:1024
    ds_read_b128 a[136:139], v29 offset:2048
    ds_read_b128 a[140:143], v29 offset:3072
    ds_read_b128 a[144:147], v29 offset:4096
    ds_read_b128 a[148:151], v29 offset:5120
    ds_read_b128 a[152:155], v29 offset:6144
    ds_read_b128 a[156:159], v29 offset:7168
    s_waitcnt lgkmcnt(0)
    v_mfma_f32_16x16x32_bf16 v[80:83], a[64:67], a[0:3], 0
    v_mfma_f32_16x16x32_bf16 v[80:83], a[68:71], a[4:7], v[80:83]
    v_mfma_f32_16x16x32_bf16 v[80:83], a[72:75], a[8:11], v[80:83]
    v_mfma_f32_16x16x32_bf16 v[80:83], a[76:79], a[12:15], v[80:83]
    v_mfma_f32_16x16x32_bf16 v[84:87], a[80:83], a[0:3], 0
    v_mfma_f32_16x16x32_bf16 v[84:87], a[84:87], a[4:7], v[84:87]
    v_mfma_f32_16x16x32_bf16 v[84:87], a[88:91], a[8:11], v[84:87]
    v_mfma_f32_16x16x32_bf16 v[84:87], a[92:95], a[12:15], v[84:87]
    s_nop 15
    v_sub_f32 v80, v80, v30
    v_sub_f32 v81, v81, v30
    v_sub_f32 v82, v82, v30
    v_sub_f32 v83, v83, v30
    v_sub_f32 v84, v84, v30
    v_sub_f32 v85, v85, v30
    v_sub_f32 v86, v86, v30
    v_sub_f32 v87, v87, v30
    v_exp_f32 v80, v80
    v_exp_f32 v81, v81
    v_exp_f32 v82, v82
    v_exp_f32 v83, v83
    v_exp_f32 v84, v84
    v_exp_f32 v85, v85
    v_exp_f32 v86, v86
    v_exp_f32 v87, v87
    s_nop 1
    v_cvt_pk_bf16_f32 v64, v80, v81
    v_cvt_pk_bf16_f32 v65, v82, v83
    v_cvt_pk_bf16_f32 v66, v84, v85
    v_cvt_pk_bf16_f32 v67, v86, v87
    s_nop 1
    v_mfma_f32_16x16x32_bf16 v[128:131], v[64:67], a[128:131], v[128:131]
    v_mfma_f32_16x16x32_bf16 v[132:135], v[64:67], a[132:135], v[132:135]
    v_mfma_f32_16x16x32_bf16 v[136:139], v[64:67], a[136:139], v[136:139]
    v_mfma_f32_16x16x32_bf16 v[140:143], v[64:67], a[140:143], v[140:143]
    v_mfma_f32_16x16x32_bf16 v[144:147], v[64:67], a[144:147], v[144:147]
    v_mfma_f32_16x16x32_bf16 v[148:151], v[64:67], a[148:151], v[148:151]
    v_mfma_f32_16x16x32_bf16 v[152:155], v[64:67], a[152:155], v[152:155]
    v_mfma_f32_16x16x32_bf16 v[156:159], v[64:67], a[156:159], v[156:159]
    v_mfma_f32_16x16x32_bf16 v[112:115], v[64:67], a[192:195], v[112:115]
    v_add_u32 v28, 0x2000, v28
    v_add_u32 v29, 0x2000, v29
    s_sub_u32 s37, s37, 1
    s_cmp_lg_u32 s37, 0
    s_cbranch_scc1 L_slow_pv
    s_nop 15
    v_rcp_f32 v24, v112
    v_rcp_f32 v25, v113
    v_rcp_f32 v26, v114
    v_rcp_f32 v27, v115
    v_mul_f32 v32, v128, v24
    v_mul_f32 v33, v132, v24
    v_mul_f32 v34, v136, v24
    v_mul_f32 v35, v140, v24
    v_mul_f32 v36, v144, v24
    v_mul_f32 v37, v148, v24
    v_mul_f32 v38, v152, v24
    v_mul_f32 v39, v156, v24
    v_mul_f32 v40, v129, v25
    v_mul_f32 v41, v133, v25
    v_mul_f32 v42, v137, v25
    v_mul_f32 v43, v141, v25
    v_mul_f32 v44, v145, v25
    v_mul_f32 v45, v149, v25
    v_mul_f32 v46, v153, v25
    v_mul_f32 v47, v157, v25
    v_mul_f32 v48, v130, v26
    v_mul_f32 v49, v134, v26
    v_mul_f32 v50, v138, v26
    v_mul_f32 v51, v142, v26
    v_mul_f32 v52, v146, v26
    v_mul_f32 v53, v150, v26
    v_mul_f32 v54, v154, v26
    v_mul_f32 v55, v158, v26
    v_mul_f32 v56, v131, v27
    v_mul_f32 v57, v135, v27
    v_mul_f32 v58, v139, v27
    v_mul_f32 v59, v143, v27
    v_mul_f32 v60, v147, v27
    v_mul_f32 v61, v151, v27
    v_mul_f32 v62, v155, v27
    v_mul_f32 v63, v159, v27
    v_cvt_pk_bf16_f32 v32, v32, v33
    v_cvt_pk_bf16_f32 v33, v34, v35
    v_cvt_pk_bf16_f32 v34, v36, v37
    v_cvt_pk_bf16_f32 v35, v38, v39
    v_cvt_pk_bf16_f32 v40, v40, v41
    v_cvt_pk_bf16_f32 v41, v42, v43
    v_cvt_pk_bf16_f32 v42, v44, v45
    v_cvt_pk_bf16_f32 v43, v46, v47
    buffer_store_dwordx4 v[32:35], v5, s[24:27], s30 offen offset:0 sc1
    v_cvt_pk_bf16_f32 v48, v48, v49
    v_cvt_pk_bf16_f32 v49, v50, v51
    v_cvt_pk_bf16_f32 v50, v52, v53
    v_cvt_pk_bf16_f32 v51, v54, v55
    buffer_store_dwordx4 v[40:43], v5, s[24:27], s30 offen offset:256 sc1
    v_cvt_pk_bf16_f32 v56, v56, v57
    v_cvt_pk_bf16_f32 v57, v58, v59
    v_cvt_pk_bf16_f32 v58, v60, v61
    v_cvt_pk_bf16_f32 v59, v62, v63
    buffer_store_dwordx4 v[48:51], v5, s[24:27], s30 offen offset:512 sc1
    buffer_store_dwordx4 v[56:59], v5, s[24:27], s30 offen offset:768 sc1
    s_add_u32 s30, s30, 0x4000
    s_branch L_slow
L_done:
L_end:
    s_endpgm
.section .rodata,"a"
.p2align 6
.amdhsa_kernel standalone__gqa_softmax__near_ridge_kernel
  .amdhsa_next_free_vgpr 456
  .amdhsa_next_free_sgpr 48
  .amdhsa_accum_offset 256
  .amdhsa_group_segment_fixed_size 0
  .amdhsa_kernarg_size 48
  .amdhsa_user_sgpr_count 2
  .amdhsa_user_sgpr_kernarg_segment_ptr 1
  .amdhsa_system_sgpr_workgroup_id_x 1
  .amdhsa_float_denorm_mode_32 3
.end_amdhsa_kernel
```
